```python
import torch

def _softmax(x, axis=-1):
    return torch.softmax(x, dim=axis)
def _gelu(x):
    return torch.nn.functional.gelu(x, approximate="tanh")
def _silu(x):
    return torch.nn.functional.silu(x)
def _sigmoid(x):
    return torch.sigmoid(x)
def _layernorm(x, axis=-1, eps=1e-5):
    m = x.mean(dim=axis, keepdim=True)
    v = x.var(dim=axis, keepdim=True, unbiased=False)
    return (x - m) / torch.sqrt(v + eps)
def _scatter_add(tgt, idx, src, axis=0):
    return tgt.clone().index_add_(axis, idx, src)
def _segment_sum(src, seg, n):
    out = torch.zeros((n,) + src.shape[1:], dtype=src.dtype)
    return out.index_add_(0, seg, src)
def _pad(x, pw):
    flat = tuple(v for pair in reversed(pw) for v in pair)
    return torch.nn.functional.pad(x, flat)

kernel_name = 'gated_mix__compressed_kv_cla__dense_activation_silu__decode'

def setup_inputs():

    _w = (lambda a: (lambda t: t.to(torch.bfloat16) if t.is_floating_point() else t)(torch.as_tensor(a)))
    def _A_setup():
        B, H, Sq, Sk, D, M = 2, 32, 1, 8192, 128, 512
        Dc = 4 * D
        return {
            "x": _w((lambda *s: torch.randn(*s, dtype=torch.bfloat16) * 0.05)(B, Sq, M)),
            "c_kv": _w((lambda *s: torch.randn(*s, dtype=torch.bfloat16) * 0.8)(B, Sk, Dc)),
            "w_q": _w((lambda *s: torch.randn(*s, dtype=torch.bfloat16) * 6.4)(M, H, D) * (M ** -0.5)),
            "w_uk": _w((lambda *s: torch.randn(*s, dtype=torch.bfloat16) * 6.4)(Dc, H, D) * (Dc ** -0.5)),
            "w_uv": _w((lambda *s: torch.randn(*s, dtype=torch.bfloat16) * 0.8)(Dc, H, D) * (Dc ** -0.5)),
            "w_o": _w((lambda *s: torch.randn(*s, dtype=torch.bfloat16) * 0.8)(H, D, M) * ((H * D) ** -0.5)),
        }
    _A_in = _A_setup()

    def _B_setup():
        B, S, D, F = 2, 1, 512, 1792
        return {
            "x": _w((lambda *s: torch.randn(*s, dtype=torch.bfloat16) * 0.05)(B, S, D)),
            "w1": _w((lambda *s: torch.randn(*s, dtype=torch.bfloat16) * 3.2)(D, F) * (D ** -0.5)),
            "w2": _w((lambda *s: torch.randn(*s, dtype=torch.bfloat16) * 1.6)(F, D) * (F ** -0.5)),
        }
    _B_in = _B_setup()

    return {
        "A_x": _A_in["x"],
        "A_c_kv": _A_in["c_kv"],
        "A_w_q": _A_in["w_q"],
        "A_w_uk": _A_in["w_uk"],
        "A_w_uv": _A_in["w_uv"],
        "A_w_o": _A_in["w_o"],
        "B_x": _B_in["x"],
        "B_w1": _B_in["w1"],
        "B_w2": _B_in["w2"],
        "gate_w": _w((lambda *s: torch.randn(*s, dtype=torch.bfloat16) * 0.05)(512) * 16.0),
    }

def reference(A_x, A_c_kv, A_w_q, A_w_uk, A_w_uv, A_w_o, B_x, B_w1, B_w2, gate_w):
    def _A_ref(x, c_kv, w_q, w_uk, w_uv, w_o):
        B, Sq, M = x.shape[0], x.shape[1], x.shape[2]
        Sk = c_kv.shape[1]
        H, D = w_q.shape[1], w_q.shape[2]
        q = torch.einsum("bqm,mhd->bhqd", x, w_q)
        k = torch.einsum("bkc,chd->bhkd", c_kv, w_uk)
        v = torch.einsum("bkc,chd->bhkd", c_kv, w_uv)
        scores = torch.einsum("bhqd,bhkd->bhqk", q, k) * (D ** -0.5)
        off = Sk - Sq
        qi = torch.arange(Sq)[:, None]
        kj = torch.arange(Sk)[None, :]
        cmask = kj <= (qi + off)
        scores = torch.where(cmask[None, None], scores, -1e9)
        p = _softmax(scores, axis=-1)
        ctx = torch.einsum("bhqk,bhkd->bhqd", p, v)
        return torch.einsum("bhqd,hdm->bqm", ctx, w_o)

    def _B_ref(x, w1, w2):
        h = torch.einsum("bsd,df->bsf", x, w1)
        h = _silu(h)
        out = torch.einsum("bsf,fd->bsd", h, w2)
        return out

    x = A_x
    g = _sigmoid((x * gate_w).sum(-1, keepdims=True))
    a = _A_ref(x, A_c_kv, A_w_q, A_w_uk, A_w_uv, A_w_o)
    b = _B_ref(x, B_w1, B_w2)
    return g * a + (1 - g) * b
```

```asm
; @launch grid=(256,1,1) block=(256,1,1) lds=163840
.amdgcn_target "amdgcn-amd-amdhsa--gfx950"
.text
.globl gated_mix__compressed_kv_cla__dense_activation_silu__decode_kernel
.p2align 8
.type gated_mix__compressed_kv_cla__dense_activation_silu__decode_kernel,@function
gated_mix__compressed_kv_cla__dense_activation_silu__decode_kernel:
    s_cmp_ge_u32 s2, 256
    s_cbranch_scc1 L_exit
    s_load_dwordx16 s[4:19], s[0:1], 0
    s_load_dwordx8 s[20:27], s[0:1], 64
    s_load_dwordx2 s[28:29], s[0:1], 96
    v_lshrrev_b32 v1, 6, v0
    s_and_b32 s30, s2, 7
    v_readfirstlane_b32 s3, v1
    s_lshr_b32 s31, s2, 3
    v_and_b32 v1, 63, v0
    v_and_b32 v2, 15, v0
    v_bfe_u32 v3, v0, 4, 2
    s_cmp_lg_u32 s3, 3
    s_cbranch_scc1 L_nopf
    s_getpc_b64 s[32:33]
L_pc:
    s_mul_i32 s34, s31, 768
    v_lshl_add_u32 v4, v1, 7, s34
    v_min_u32 v4, L_exit-L_pc, v4
    s_mov_b64 exec, 63
    global_load_dword v127, v4, s[32:33]
    s_mov_b64 exec, -1
L_nopf:
    s_cmp_lt_u32 s31, 16
    s_cbranch_scc0 L_att
    s_lshr_b32 s60, s31, 2
    s_lshl_b32 s61, s30, 2
    s_add_u32 s60, s60, s61
    s_and_b32 s61, s31, 3
    v_lshlrev_b32 v5, 4, v2
    v_lshl_add_u32 v5, v3, 18, v5
    s_lshl_b32 s64, s3, 20
    s_lshl_b32 s65, s60, 8
    s_add_u32 s64, s64, s65
    s_lshl_b32 s66, s61, 16
    s_add_u32 s63, s64, s66
    s_mov_b32 s42, 0x400000
    s_mov_b32 s43, 0x20000
    s_movk_i32 s67, 0x2000
    s_waitcnt lgkmcnt(0)
    s_mov_b64 s[40:41], s[8:9]
    buffer_load_dwordx4 a[0:3], v5, s[40:43], s63 offen
    s_add_u32 s63, s63, s67
    buffer_load_dwordx4 a[4:7], v5, s[40:43], s63 offen
    s_add_u32 s63, s63, s67
    buffer_load_dwordx4 a[8:11], v5, s[40:43], s63 offen
    s_add_u32 s63, s63, s67
    buffer_load_dwordx4 a[12:15], v5, s[40:43], s63 offen
    s_add_u32 s63, s63, s67
    buffer_load_dwordx4 a[16:19], v5, s[40:43], s63 offen
    s_add_u32 s63, s63, s67
    buffer_load_dwordx4 a[20:23], v5, s[40:43], s63 offen
    s_add_u32 s63, s63, s67
    buffer_load_dwordx4 a[24:27], v5, s[40:43], s63 offen
    s_add_u32 s63, s63, s67
    buffer_load_dwordx4 a[28:31], v5, s[40:43], s63 offen
    s_add_u32 s66, s66, 0x10000
    s_and_b32 s66, s66, 0x3ffff
    s_branch L_wgt
L_att:
    s_sub_u32 s61, s31, 16
    s_lshl_b32 s60, s61, 3
    s_add_u32 s60, s60, s30
    v_lshlrev_b32 v9, 4, v1
    v_lshlrev_b32 v124, 7, v1
    s_lshl_b32 s62, s60, 17
    s_lshl_b32 s63, s3, 15
    s_add_u32 s62, s62, s63
    s_mul_i32 s52, s61, 2
    s_mul_i32 s53, s30, 0
    s_add_u32 s52, s52, s53
    s_mul_i32 s53, s3, 0
    s_add_u32 s52, s52, s53
    s_and_b32 s52, s52, 31
    s_lshl_b32 s52, s52, 10
    s_mov_b32 s61, s62
    s_add_u32 s62, s62, s52
    s_mul_i32 s63, s3, 16896
    s_mov_b32 m0, s63
    s_waitcnt lgkmcnt(0)
    s_mov_b32 s40, s6
    s_mov_b32 s41, s7
    s_mov_b32 s42, 16777216
    s_mov_b32 s43, 0x20000
    buffer_load_dwordx4 v9, s[40:43], s62 offen  lds
    s_add_u32 m0, m0, 1056
    s_add_u32 s62, s62, 1024
    s_and_b32 s62, s62, 0x7fff
    s_or_b32 s62, s62, s61
    buffer_load_dwordx4 v9, s[40:43], s62 offen  lds
    s_add_u32 m0, m0, 1056
    s_add_u32 s62, s62, 1024
    s_and_b32 s62, s62, 0x7fff
    s_or_b32 s62, s62, s61
    buffer_load_dwordx4 v9, s[40:43], s62 offen  lds
    s_add_u32 m0, m0, 1056
    s_add_u32 s62, s62, 1024
    s_and_b32 s62, s62, 0x7fff
    s_or_b32 s62, s62, s61
    buffer_load_dwordx4 v9, s[40:43], s62 offen  lds
    s_add_u32 m0, m0, 1056
    s_add_u32 s62, s62, 1024
    s_and_b32 s62, s62, 0x7fff
    s_or_b32 s62, s62, s61
    s_mov_b32 s36, s28
    s_mov_b32 s37, s29
    s_mov_b32 s38, 268435456
    s_mov_b32 s39, 0x20000
    v_mul_u32_u24 v125, 1381632, v1
    v_add_u32 v125, 2129920, v125
    v_mov_b32 v126, 196608
    v_cmp_gt_u32 vcc, 4, v1
    s_nop 1
    v_cndmask_b32 v125, v126, v125, vcc
    buffer_load_dword v126, v125, s[36:39], 0 offen sc1
    s_mov_b32 s32, s4
    s_mov_b32 s33, s5
    s_mov_b32 s34, 2048
    s_mov_b32 s35, 0x20000
    s_mov_b32 s59, m0
    s_and_b32 s58, s3, 1
    s_lshl_b32 s58, s58, 10
    s_add_u32 m0, s58, 143872
    s_nop 0
    buffer_load_dwordx4 v9, s[32:35], s58 offen lds
    s_mov_b32 m0, s59
    s_mov_b64 exec, 1
    s_mov_b32 s44, s18
    s_mov_b32 s45, s19
    s_mov_b32 s46, 1835008
    s_mov_b32 s47, 0x20000
    buffer_load_dword v127, off, s[44:47], 0
    s_mov_b32 s44, s20
    s_mov_b32 s45, s21
    s_mov_b32 s46, 1835008
    s_mov_b32 s47, 0x20000
    buffer_load_dword v127, off, s[44:47], 0
    s_mov_b64 exec, -1
    s_mov_b32 s57, 526336
    v_mul_lo_u32 v46, s57, v3
    v_lshl_add_u32 v46, v2, 4, v46
    s_mul_i32 s58, s3, 32896
    s_lshl_b32 s59, s60, 8
    s_add_u32 s58, s58, s59
    s_add_u32 s58, s58, 2097152
    s_lshl_b32 s57, s60, 9
    s_add_u32 s57, s57, 65536
    s_lshr_b32 s56, s60, 3
    s_lshl_b32 s56, s56, 10
    s_lshl_b32 s59, s30, 7
    s_add_u32 s56, s56, s59
    s_add_u32 s55, s56, 393216
    s_add_u32 s56, s56, 262144
    v_lshlrev_b32 v38, 14, v1
    v_mul_u32_u24 v5, 1056, v2
    v_lshl_add_u32 v5, v3, 4, v5
    v_add_u32 v47, 0, v5
    v_add_u32 v5, s63, v5
    v_add_u32 v6, 67584, v5
    v_lshrrev_b32 v7, 2, v2
    v_lshl_add_u32 v7, v3, 2, v7
    v_mul_u32_u24 v7, 1056, v7
    v_and_b32 v8, 3, v2
    v_lshl_add_u32 v7, v8, 3, v7
    s_lshl_b32 s64, s3, 8
    v_add_u32 v7, s64, v7
    v_add_u32 v8, 67584, v7
    s_mov_b32 s8, s10
    s_mov_b32 s9, s11
    s_mov_b32 s10, 4194304
    s_mov_b32 s11, 0x20000
    v_lshrrev_b32 v10, 3, v1
    v_lshlrev_b32 v10, 13, v10
    v_and_b32 v11, 7, v1
    v_lshl_add_u32 v10, v11, 7, v10
    s_lshr_b32 s7, s60, 3
    s_lshl_b32 s7, s7, 18
    s_lshl_b32 s67, s3, 16
    s_add_u32 s7, s7, s67
    s_and_b32 s67, s60, 7
    s_lshl_b32 s67, s67, 10
    s_add_u32 s7, s7, s67
    buffer_load_dword v127, v10, s[8:11], s7 offen
    s_waitcnt vmcnt(4)
    v_readlane_b32 s16, v126, 8
    s_nop 0
    s_add_u32 s17, s16, 1
    s_and_b32 s17, s17, 0x3f
    s_andn2_b32 s99, 3, s17
    s_lshl_b32 s99, s99, 6
    s_or_b32 s17, s17, s99
    s_add_u32 s16, s16, 0x100
    s_andn2_b32 s16, s16, 0xff
    s_or_b32 s16, s16, s17
    s_bfe_u32 s67, s17, 0x10001
    s_lshl_b32 s67, s67, 16
    s_bfe_u32 s99, s17, 0x10000
    s_or_b32 s99, s99, s67
    s_bfe_u32 s67, s17, 0x10003
    s_lshl_b32 s67, s67, 16
    s_bfe_u32 s100, s17, 0x10002
    s_or_b32 s100, s100, s67
    s_bfe_u32 s67, s17, 0x10005
    s_lshl_b32 s67, s67, 16
    s_bfe_u32 s101, s17, 0x10004
    s_or_b32 s101, s101, s67
    s_bfe_u32 s67, s17, 0x10007
    s_lshl_b32 s67, s67, 16
    s_bfe_u32 s31, s17, 0x10006
    s_or_b32 s31, s31, s67
    v_mov_b32 v39, s16
    s_lshr_b32 s64, s60, 6
    s_lshl_b32 s64, s64, 15
    s_lshl_b32 s65, s3, 13
    s_add_u32 s64, s64, s65
    s_add_u32 s65, s64, 4096
    s_mul_i32 s66, s3, 8448
    v_add_u32 v11, s66, v9
    v_and_b32 v12, 31, v1
    v_lshlrev_b32 v12, 4, v12
    s_lshl_b32 s52, s3, 2
    s_add_u32 s52, s52, 143360
    v_add_u32 v12, s52, v12
    v_lshlrev_b32 v10, 4, v2
    v_add_u32 v13, 143360, v10
    s_lshl_b32 s52, s3, 11
    s_add_u32 s52, s52, 135168
    v_add_u32 v14, s52, v9
    v_add_u32 v15, 135168, v9
    s_and_b32 s52, s3, 1
    s_lshl_b32 s53, s52, 10
    v_add_u32 v45, s53, v15
    s_lshl_b32 s53, s52, 8
    s_add_u32 s57, s57, s53
    s_cmp_eq_u32 s52, 1
    s_cselect_b64 s[68:69], -1, 0
    v_mov_b32 v40, 0x3f803f80
    v_mov_b32 v41, 0x3f803f80
    v_mov_b32 v42, 0x3f803f80
    v_mov_b32 v43, 0x3f803f80
    v_mov_b32 v58, s16
    v_mov_b32 v59, s16
    v_mov_b32 v4, 0xfffefffe
    s_mov_b32 s6, 0x10000
    s_lshr_b32 s52, s60, 5
    s_lshl_b32 s53, s30, 2
    s_add_u32 s52, s52, s53
    s_bfe_u32 s53, s60, 0x20003
    s_lshl_b32 s54, s52, 2
    s_add_u32 s54, s54, s53
    s_lshl_b32 s53, s54, 5
    s_mul_i32 s52, s3, 458752
    s_add_u32 s53, s53, s52
    s_lshl_b32 s52, s54, 14
    s_lshl_b32 s30, s3, 8
    s_add_u32 s52, s52, s30
    s_lshl_b32 s30, s3, 13
    s_add_u32 s30, s30, 33792
    v_lshrrev_b32 v60, 1, v1
    v_mul_u32_u24 v60, 3584, v60
    v_and_b32 v61, 1, v1
    v_lshl_add_u32 v60, v61, 4, v60
    v_lshlrev_b32 v61, 1, v3
    v_xor_b32 v61, v61, v2
    v_xor_b32 v62, 8, v61
    v_lshlrev_b32 v61, 4, v61
    v_lshlrev_b32 v62, 4, v62
    v_lshl_add_u32 v61, v3, 10, v61
    v_lshl_add_u32 v62, v3, 10, v62
    v_lshlrev_b32 v13, 2, v2
    v_add_u32 v13, 143360, v13
    v_mov_b32 v16, 0xff800000
    ds_write_b32 v13, v16
    ds_write_b32 v13, v16 offset:64
    s_lshl_b32 s59, s3, 8
    s_lshl_b32 s57, s60, 9
    s_add_u32 s57, s57, s59
    s_add_u32 s57, s57, 65536
    buffer_load_dwordx4 v9, s[40:43], s62 offen  lds
    s_add_u32 m0, m0, 1056
    s_add_u32 s62, s62, 1024
    s_and_b32 s62, s62, 0x7fff
    s_or_b32 s62, s62, s61
    buffer_load_dwordx4 v9, s[40:43], s62 offen  lds
    s_add_u32 m0, m0, 1056
    s_add_u32 s62, s62, 1024
    s_and_b32 s62, s62, 0x7fff
    s_or_b32 s62, s62, s61
    buffer_load_dwordx4 v9, s[40:43], s62 offen  lds
    s_add_u32 m0, m0, 1056
    s_add_u32 s62, s62, 1024
    s_and_b32 s62, s62, 0x7fff
    s_or_b32 s62, s62, s61
    buffer_load_dwordx4 v9, s[40:43], s62 offen  lds
    s_add_u32 m0, m0, 1056
    s_add_u32 s62, s62, 1024
    s_and_b32 s62, s62, 0x7fff
    s_or_b32 s62, s62, s61
    buffer_load_dwordx4 v9, s[40:43], s62 offen  lds
    s_add_u32 m0, m0, 1056
    s_add_u32 s62, s62, 1024
    s_and_b32 s62, s62, 0x7fff
    s_or_b32 s62, s62, s61
    buffer_load_dwordx4 v9, s[40:43], s62 offen  lds
    s_add_u32 m0, m0, 1056
    s_add_u32 s62, s62, 1024
    s_and_b32 s62, s62, 0x7fff
    s_or_b32 s62, s62, s61
    buffer_load_dwordx4 v9, s[40:43], s62 offen  lds
    s_add_u32 m0, m0, 1056
    s_add_u32 s62, s62, 1024
    s_and_b32 s62, s62, 0x7fff
    s_or_b32 s62, s62, s61
    buffer_load_dwordx4 v9, s[40:43], s62 offen  lds
    s_add_u32 m0, m0, 1056
    s_add_u32 s62, s62, 1024
    s_and_b32 s62, s62, 0x7fff
    s_or_b32 s62, s62, s61
    buffer_load_dwordx4 v9, s[40:43], s62 offen  lds
    s_add_u32 m0, m0, 1056
    s_add_u32 s62, s62, 1024
    s_and_b32 s62, s62, 0x7fff
    s_or_b32 s62, s62, s61
    buffer_load_dwordx4 v9, s[40:43], s62 offen  lds
    s_add_u32 m0, m0, 1056
    s_add_u32 s62, s62, 1024
    s_and_b32 s62, s62, 0x7fff
    s_or_b32 s62, s62, s61
    buffer_load_dwordx4 v9, s[40:43], s62 offen  lds
    s_add_u32 m0, m0, 1056
    s_add_u32 s62, s62, 1024
    s_and_b32 s62, s62, 0x7fff
    s_or_b32 s62, s62, s61
    buffer_load_dwordx4 v9, s[40:43], s62 offen  lds
    s_add_u32 m0, m0, 1056
    s_add_u32 s62, s62, 1024
    s_and_b32 s62, s62, 0x7fff
    s_or_b32 s62, s62, s61
    s_add_u32 m0, s63, 67584
    s_nop 0
    buffer_load_dwordx4 v9, s[40:43], s62 offen  lds
    s_add_u32 m0, m0, 1056
    s_add_u32 s62, s62, 1024
    s_and_b32 s62, s62, 0x7fff
    s_or_b32 s62, s62, s61
    buffer_load_dwordx4 v9, s[40:43], s62 offen  lds
    s_add_u32 m0, m0, 1056
    s_add_u32 s62, s62, 1024
    s_and_b32 s62, s62, 0x7fff
    s_or_b32 s62, s62, s61
    buffer_load_dwordx4 v9, s[40:43], s62 offen  lds
    s_add_u32 m0, m0, 1056
    s_add_u32 s62, s62, 1024
    s_and_b32 s62, s62, 0x7fff
    s_or_b32 s62, s62, s61
    buffer_load_dwordx4 v9, s[40:43], s62 offen  lds
    s_add_u32 m0, m0, 1056
    s_add_u32 s62, s62, 1024
    s_and_b32 s62, s62, 0x7fff
    s_or_b32 s62, s62, s61
    buffer_load_dwordx4 v9, s[40:43], s62 offen  lds
    s_add_u32 m0, m0, 1056
    s_add_u32 s62, s62, 1024
    s_and_b32 s62, s62, 0x7fff
    s_or_b32 s62, s62, s61
    buffer_load_dwordx4 v9, s[40:43], s62 offen  lds
    s_add_u32 m0, m0, 1056
    s_add_u32 s62, s62, 1024
    s_and_b32 s62, s62, 0x7fff
    s_or_b32 s62, s62, s61
    buffer_load_dwordx4 v9, s[40:43], s62 offen  lds
    s_add_u32 m0, m0, 1056
    s_add_u32 s62, s62, 1024
    s_and_b32 s62, s62, 0x7fff
    s_or_b32 s62, s62, s61
    buffer_load_dwordx4 v9, s[40:43], s62 offen  lds
    s_add_u32 m0, m0, 1056
    s_add_u32 s62, s62, 1024
    s_and_b32 s62, s62, 0x7fff
    s_or_b32 s62, s62, s61
    buffer_load_dwordx4 v9, s[40:43], s62 offen  lds
    s_add_u32 m0, m0, 1056
    s_add_u32 s62, s62, 1024
    s_and_b32 s62, s62, 0x7fff
    s_or_b32 s62, s62, s61
    buffer_load_dwordx4 v9, s[40:43], s62 offen  lds
    s_add_u32 m0, m0, 1056
    s_add_u32 s62, s62, 1024
    s_and_b32 s62, s62, 0x7fff
    s_or_b32 s62, s62, s61
    s_waitcnt vmcnt(10)
    s_waitcnt lgkmcnt(7)
    ds_read_b128 a[0:3], v5 offset:0
    ds_read_b128 a[4:7], v5 offset:64
    ds_read_b128 a[8:11], v5 offset:128
    ds_read_b128 a[12:15], v5 offset:192
    ds_read_b128 a[16:19], v5 offset:256
    ds_read_b128 a[20:23], v5 offset:320
    ds_read_b128 a[24:27], v5 offset:384
    ds_read_b128 a[28:31], v5 offset:448
    buffer_load_dwordx4 v9, s[40:43], s62 offen  lds
    s_add_u32 m0, m0, 1056
    s_add_u32 s62, s62, 1024
    s_and_b32 s62, s62, 0x7fff
    s_or_b32 s62, s62, s61
    s_waitcnt lgkmcnt(7)
    ds_read_b128 a[32:35], v5 offset:512
    ds_read_b128 a[36:39], v5 offset:576
    ds_read_b128 a[40:43], v5 offset:640
    ds_read_b128 a[44:47], v5 offset:704
    ds_read_b128 a[48:51], v5 offset:768
    ds_read_b128 a[52:55], v5 offset:832
    ds_read_b128 a[56:59], v5 offset:896
    ds_read_b128 a[60:63], v5 offset:960
    buffer_load_dwordx4 v9, s[40:43], s62 offen  lds
    s_add_u32 m0, m0, 1056
    s_add_u32 s62, s62, 1024
    s_and_b32 s62, s62, 0x7fff
    s_or_b32 s62, s62, s61
    s_barrier
    s_waitcnt lgkmcnt(7)
    ds_read_b64_tr_b16 a[128:129], v7 offset:0
    ds_read_b64_tr_b16 a[132:133], v7 offset:16896
    ds_read_b64_tr_b16 a[136:137], v7 offset:33792
    ds_read_b64_tr_b16 a[140:141], v7 offset:50688
    ds_read_b64_tr_b16 a[144:145], v7 offset:32
    ds_read_b64_tr_b16 a[148:149], v7 offset:16928
    ds_read_b64_tr_b16 a[152:153], v7 offset:33824
    ds_read_b64_tr_b16 a[156:157], v7 offset:50720
    buffer_load_dwordx4 v9, s[40:43], s62 offen  lds
    s_add_u32 m0, m0, 1056
    s_add_u32 s62, s62, 1024
    s_and_b32 s62, s62, 0x7fff
    s_or_b32 s62, s62, s61
    s_waitcnt lgkmcnt(7)
    ds_read_b64_tr_b16 a[160:161], v7 offset:64
    ds_read_b64_tr_b16 a[164:165], v7 offset:16960
    ds_read_b64_tr_b16 a[168:169], v7 offset:33856
    ds_read_b64_tr_b16 a[172:173], v7 offset:50752
    ds_read_b64_tr_b16 a[176:177], v7 offset:96
    ds_read_b64_tr_b16 a[180:181], v7 offset:16992
    ds_read_b64_tr_b16 a[184:185], v7 offset:33888
    ds_read_b64_tr_b16 a[188:189], v7 offset:50784
    buffer_load_dwordx4 v9, s[40:43], s62 offen  lds
    s_add_u32 m0, m0, 1056
    s_add_u32 s62, s62, 1024
    s_and_b32 s62, s62, 0x7fff
    s_or_b32 s62, s62, s61
    s_waitcnt lgkmcnt(7)
    ds_read_b64_tr_b16 a[192:193], v7 offset:128
    ds_read_b64_tr_b16 a[196:197], v7 offset:17024
    ds_read_b64_tr_b16 a[200:201], v7 offset:33920
    ds_read_b64_tr_b16 a[204:205], v7 offset:50816
    ds_read_b64_tr_b16 a[208:209], v7 offset:160
    ds_read_b64_tr_b16 a[212:213], v7 offset:17056
    ds_read_b64_tr_b16 a[216:217], v7 offset:33952
    ds_read_b64_tr_b16 a[220:221], v7 offset:50848
    buffer_load_dwordx4 v9, s[40:43], s62 offen  lds
    s_add_u32 m0, m0, 1056
    s_add_u32 s62, s62, 1024
    s_and_b32 s62, s62, 0x7fff
    s_or_b32 s62, s62, s61
    s_waitcnt lgkmcnt(7)
    ds_read_b64_tr_b16 a[224:225], v7 offset:192
    ds_read_b64_tr_b16 a[228:229], v7 offset:17088
    ds_read_b64_tr_b16 a[232:233], v7 offset:33984
    ds_read_b64_tr_b16 a[236:237], v7 offset:50880
    ds_read_b64_tr_b16 a[240:241], v7 offset:224
    ds_read_b64_tr_b16 a[244:245], v7 offset:17120
    ds_read_b64_tr_b16 a[248:249], v7 offset:34016
    ds_read_b64_tr_b16 a[252:253], v7 offset:50912
    buffer_load_dwordx4 v9, s[40:43], s62 offen  lds
    s_add_u32 m0, m0, 1056
    s_add_u32 s62, s62, 1024
    s_and_b32 s62, s62, 0x7fff
    s_or_b32 s62, s62, s61
    s_waitcnt lgkmcnt(0)
    s_barrier
    s_mov_b32 s40, s18
    s_mov_b32 s41, s19
    s_mov_b32 s42, 1835008
    s_mov_b32 s43, 0x20000
    s_mov_b32 s44, s20
    s_mov_b32 s45, s21
    s_mov_b32 s46, 1835008
    s_mov_b32 s47, 0x20000
    s_lshr_b32 s61, s60, 3
    s_lshl_b32 s61, s61, 2
    s_add_u32 s61, s61, s3
    s_mul_i32 s61, s61, 28672
    s_lshr_b32 s62, s54, 4
    s_lshl_b32 s62, s62, 9
    s_add_u32 s61, s61, s62
    s_lshl_b32 s62, s54, 14
    s_lshl_b32 s59, s3, 12
    s_add_u32 s62, s62, s59
    v_and_b32 v37, 31, v1
    v_mul_u32_u24 v36, 3584, v37
    v_lshrrev_b32 v36, 2, v37
    v_mul_u32_u24 v36, 3584, v36
    v_and_b32 v63, 3, v1
    v_lshl_add_u32 v36, v63, 7, v36
    v_lshlrev_b32 v37, 7, v37
    buffer_load_dwordx4 v[128:131], v9, s[36:39], s64 offen offset:0 sc1
    buffer_load_dwordx4 v[132:135], v9, s[36:39], s64 offen offset:1024 sc1
    buffer_load_dwordx4 v[136:139], v9, s[36:39], s64 offen offset:2048 sc1
    buffer_load_dwordx4 v[140:143], v9, s[36:39], s64 offen offset:3072 sc1
    buffer_load_dwordx4 v[144:147], v9, s[36:39], s65 offen offset:0 sc1
    buffer_load_dwordx4 v[148:151], v9, s[36:39], s65 offen offset:1024 sc1
    buffer_load_dwordx4 v[152:155], v9, s[36:39], s65 offen offset:2048 sc1
    buffer_load_dwordx4 v[156:159], v9, s[36:39], s65 offen offset:3072 sc1
    s_waitcnt vmcnt(8)
    ds_read_b128 a[64:67], v6 offset:0
    ds_read_b128 a[68:71], v6 offset:64
    ds_read_b128 a[72:75], v6 offset:128
    ds_read_b128 a[76:79], v6 offset:192
    ds_read_b128 a[80:83], v6 offset:256
    ds_read_b128 a[84:87], v6 offset:320
    ds_read_b128 a[88:91], v6 offset:384
    ds_read_b128 a[92:95], v6 offset:448
    ds_read_b128 a[96:99], v6 offset:512
    ds_read_b128 a[100:103], v6 offset:576
    ds_read_b128 a[104:107], v6 offset:640
    ds_read_b128 a[108:111], v6 offset:704
    ds_read_b128 a[112:115], v6 offset:768
    s_waitcnt lgkmcnt(12)
    ds_read_b128 a[116:119], v6 offset:832
    s_waitcnt lgkmcnt(12)
    ds_read_b128 a[120:123], v6 offset:896
    s_waitcnt lgkmcnt(12)
    ds_read_b128 a[124:127], v6 offset:960
    s_waitcnt lgkmcnt(12)
    s_mov_b32 s67, 0
L_a_qchk:
    s_add_u32 s67, s67, 1
    s_waitcnt lgkmcnt(7)
    s_waitcnt vmcnt(7)
    v_xor_b32 v128, s99, v128
    v_xor_b32 v129, s100, v129
    v_xor_b32 v130, s101, v130
    v_xor_b32 v131, s31, v131
    ds_write_b128 v11, v[128:131] offset:0
    v_or3_b32 v16, v128, v129, v130
    v_or_b32 v16, v16, v131
    s_waitcnt vmcnt(6)
    v_xor_b32 v132, s99, v132
    v_xor_b32 v133, s100, v133
    v_xor_b32 v134, s101, v134
    v_xor_b32 v135, s31, v135
    ds_write_b128 v11, v[132:135] offset:1056
    v_or3_b32 v16, v16, v132, v133
    v_or3_b32 v16, v16, v134, v135
    s_waitcnt vmcnt(5)
    v_xor_b32 v136, s99, v136
    v_xor_b32 v137, s100, v137
    v_xor_b32 v138, s101, v138
    v_xor_b32 v139, s31, v139
    ds_write_b128 v11, v[136:139] offset:2112
    v_or3_b32 v16, v16, v136, v137
    v_or3_b32 v16, v16, v138, v139
    s_waitcnt vmcnt(4)
    v_xor_b32 v140, s99, v140
    v_xor_b32 v141, s100, v141
    v_xor_b32 v142, s101, v142
    v_xor_b32 v143, s31, v143
    ds_write_b128 v11, v[140:143] offset:3168
    v_or3_b32 v16, v16, v140, v141
    v_or3_b32 v16, v16, v142, v143
    s_waitcnt vmcnt(3)
    v_xor_b32 v144, s99, v144
    v_xor_b32 v145, s100, v145
    v_xor_b32 v146, s101, v146
    v_xor_b32 v147, s31, v147
    ds_write_b128 v11, v[144:147] offset:4224
    v_or3_b32 v16, v16, v144, v145
    v_or3_b32 v16, v16, v146, v147
    s_waitcnt vmcnt(2)
    v_xor_b32 v148, s99, v148
    v_xor_b32 v149, s100, v149
    v_xor_b32 v150, s101, v150
    v_xor_b32 v151, s31, v151
    ds_write_b128 v11, v[148:151] offset:5280
    v_or3_b32 v16, v16, v148, v149
    v_or3_b32 v16, v16, v150, v151
    s_waitcnt vmcnt(1)
    v_xor_b32 v152, s99, v152
    v_xor_b32 v153, s100, v153
    v_xor_b32 v154, s101, v154
    v_xor_b32 v155, s31, v155
    ds_write_b128 v11, v[152:155] offset:6336
    v_or3_b32 v16, v16, v152, v153
    v_or3_b32 v16, v16, v154, v155
    s_waitcnt vmcnt(0)
    v_xor_b32 v156, s99, v156
    v_xor_b32 v157, s100, v157
    v_xor_b32 v158, s101, v158
    v_xor_b32 v159, s31, v159
    ds_write_b128 v11, v[156:159] offset:7392
    v_or3_b32 v16, v16, v156, v157
    v_or3_b32 v16, v16, v158, v159
    v_and_b32 v16, 0x10001, v16
    v_cmp_ne_u32 vcc, 0, v16
    s_nop 0
    s_cbranch_vccz L_a_qok
    s_cmp_ge_u32 s67, 150000
    s_cbranch_scc1 L_a_qok
    buffer_load_dwordx4 v[128:131], v9, s[36:39], s64 offen offset:0 sc1
    buffer_load_dwordx4 v[132:135], v9, s[36:39], s64 offen offset:1024 sc1
    buffer_load_dwordx4 v[136:139], v9, s[36:39], s64 offen offset:2048 sc1
    buffer_load_dwordx4 v[140:143], v9, s[36:39], s64 offen offset:3072 sc1
    buffer_load_dwordx4 v[144:147], v9, s[36:39], s65 offen offset:0 sc1
    buffer_load_dwordx4 v[148:151], v9, s[36:39], s65 offen offset:1024 sc1
    buffer_load_dwordx4 v[152:155], v9, s[36:39], s65 offen offset:2048 sc1
    buffer_load_dwordx4 v[156:159], v9, s[36:39], s65 offen offset:3072 sc1
    s_branch L_a_qchk
L_a_qok:
    s_waitcnt lgkmcnt(0)
    s_barrier
    ds_read_b128 v[128:131], v47 offset:0
    ds_read_b128 v[132:135], v47 offset:64
    ds_read_b128 v[136:139], v47 offset:128
    ds_read_b128 v[140:143], v47 offset:192
    ds_read_b128 v[144:147], v47 offset:256
    ds_read_b128 v[148:151], v47 offset:320
    s_waitcnt lgkmcnt(5)
    v_mfma_f32_16x16x32_bf16 v[16:19], a[0:3], v[128:131], 0
    ds_read_b128 v[152:155], v47 offset:384
    ds_read_b64_tr_b16 a[130:131], v8 offset:0
    v_mfma_f32_16x16x32_bf16 v[24:27], a[64:67], v[128:131], 0
    ds_read_b64_tr_b16 a[134:135], v8 offset:16896
    s_cmp_ge_u32 s54, 112
    s_cbranch_scc1 L_a_nofpf
    s_mov_b32 exec_hi, 0
    buffer_load_dword v63, v36, s[40:43], s61 offen
    buffer_load_dword v63, v37, s[44:47], s62 offen
    s_mov_b32 exec_hi, -1
L_a_nofpf:
    s_waitcnt lgkmcnt(7)
    v_mfma_f32_16x16x32_bf16 v[16:19], a[4:7], v[132:135], v[16:19]
    ds_read_b128 v[156:159], v47 offset:448
    ds_read_b64_tr_b16 a[138:139], v8 offset:33792
    v_mfma_f32_16x16x32_bf16 v[24:27], a[68:71], v[132:135], v[24:27]
    ds_read_b64_tr_b16 a[142:143], v8 offset:50688
    s_waitcnt lgkmcnt(9)
    v_mfma_f32_16x16x32_bf16 v[16:19], a[8:11], v[136:139], v[16:19]
    ds_read_b128 v[160:163], v47 offset:512
    ds_read_b64_tr_b16 a[146:147], v8 offset:32
    v_mfma_f32_16x16x32_bf16 v[24:27], a[72:75], v[136:139], v[24:27]
    ds_read_b64_tr_b16 a[150:151], v8 offset:16928
    s_waitcnt lgkmcnt(11)
    v_mfma_f32_16x16x32_bf16 v[16:19], a[12:15], v[140:143], v[16:19]
    ds_read_b128 v[164:167], v47 offset:576
    ds_read_b64_tr_b16 a[154:155], v8 offset:33824
    v_mfma_f32_16x16x32_bf16 v[24:27], a[76:79], v[140:143], v[24:27]
    ds_read_b64_tr_b16 a[158:159], v8 offset:50720
    s_waitcnt lgkmcnt(13)
    v_mfma_f32_16x16x32_bf16 v[16:19], a[16:19], v[144:147], v[16:19]
    ds_read_b128 v[168:171], v47 offset:640
    ds_read_b64_tr_b16 a[162:163], v8 offset:64
    v_mfma_f32_16x16x32_bf16 v[24:27], a[80:83], v[144:147], v[24:27]
    s_waitcnt lgkmcnt(11)
    ds_read_b64_tr_b16 a[166:167], v8 offset:16960
    v_mfma_f32_16x16x32_bf16 v[16:19], a[20:23], v[148:151], v[16:19]
    ds_read_b128 v[172:175], v47 offset:704
    ds_read_b64_tr_b16 a[170:171], v8 offset:33856
    v_mfma_f32_16x16x32_bf16 v[24:27], a[84:87], v[148:151], v[24:27]
    ds_read_b64_tr_b16 a[174:175], v8 offset:50752
    v_mfma_f32_16x16x32_bf16 v[16:19], a[24:27], v[152:155], v[16:19]
    s_waitcnt lgkmcnt(11)
    ds_read_b128 v[176:179], v47 offset:768
    ds_read_b64_tr_b16 a[178:179], v8 offset:96
    v_mfma_f32_16x16x32_bf16 v[24:27], a[88:91], v[152:155], v[24:27]
    ds_read_b64_tr_b16 a[182:183], v8 offset:16992
    v_mfma_f32_16x16x32_bf16 v[16:19], a[28:31], v[156:159], v[16:19]
    ds_read_b128 v[180:183], v47 offset:832
    s_waitcnt lgkmcnt(11)
    ds_read_b64_tr_b16 a[186:187], v8 offset:33888
    v_mfma_f32_16x16x32_bf16 v[24:27], a[92:95], v[156:159], v[24:27]
    ds_read_b64_tr_b16 a[190:191], v8 offset:50784
    v_mfma_f32_16x16x32_bf16 v[16:19], a[32:35], v[160:163], v[16:19]
    ds_read_b128 v[184:187], v47 offset:896
    ds_read_b64_tr_b16 a[194:195], v8 offset:128
    v_mfma_f32_16x16x32_bf16 v[24:27], a[96:99], v[160:163], v[24:27]
    s_waitcnt lgkmcnt(11)
    ds_read_b64_tr_b16 a[198:199], v8 offset:17024
    v_mfma_f32_16x16x32_bf16 v[16:19], a[36:39], v[164:167], v[16:19]
    ds_read_b128 v[188:191], v47 offset:960
    ds_read_b64_tr_b16 a[202:203], v8 offset:33920
    v_mfma_f32_16x16x32_bf16 v[24:27], a[100:103], v[164:167], v[24:27]
    ds_read_b64_tr_b16 a[206:207], v8 offset:50816
    v_mfma_f32_16x16x32_bf16 v[16:19], a[40:43], v[168:171], v[16:19]
    s_waitcnt lgkmcnt(11)
    ds_read_b128 v[192:195], v47 offset:16896
    ds_read_b64_tr_b16 a[210:211], v8 offset:160
    v_mfma_f32_16x16x32_bf16 v[24:27], a[104:107], v[168:171], v[24:27]
    ds_read_b64_tr_b16 a[214:215], v8 offset:17056
    v_mfma_f32_16x16x32_bf16 v[16:19], a[44:47], v[172:175], v[16:19]
    ds_read_b128 v[196:199], v47 offset:16960
    s_waitcnt lgkmcnt(11)
    ds_read_b64_tr_b16 a[218:219], v8 offset:33952
    v_mfma_f32_16x16x32_bf16 v[24:27], a[108:111], v[172:175], v[24:27]
    ds_read_b64_tr_b16 a[222:223], v8 offset:50848
    v_mfma_f32_16x16x32_bf16 v[16:19], a[48:51], v[176:179], v[16:19]
    ds_read_b128 v[200:203], v47 offset:17024
    ds_read_b64_tr_b16 a[226:227], v8 offset:192
    v_mfma_f32_16x16x32_bf16 v[24:27], a[112:115], v[176:179], v[24:27]
    s_waitcnt lgkmcnt(11)
    ds_read_b64_tr_b16 a[230:231], v8 offset:17088
    v_mfma_f32_16x16x32_bf16 v[16:19], a[52:55], v[180:183], v[16:19]
    ds_read_b128 v[204:207], v47 offset:17088
    ds_read_b64_tr_b16 a[234:235], v8 offset:33984
    v_mfma_f32_16x16x32_bf16 v[24:27], a[116:119], v[180:183], v[24:27]
    ds_read_b64_tr_b16 a[238:239], v8 offset:50880
    v_mfma_f32_16x16x32_bf16 v[16:19], a[56:59], v[184:187], v[16:19]
    s_waitcnt lgkmcnt(11)
    ds_read_b128 v[208:211], v47 offset:17152
    ds_read_b64_tr_b16 a[242:243], v8 offset:224
    v_mfma_f32_16x16x32_bf16 v[24:27], a[120:123], v[184:187], v[24:27]
    ds_read_b64_tr_b16 a[246:247], v8 offset:17120
    v_mfma_f32_16x16x32_bf16 v[16:19], a[60:63], v[188:191], v[16:19]
    ds_read_b128 v[212:215], v47 offset:17216
    s_waitcnt lgkmcnt(11)
    ds_read_b64_tr_b16 a[250:251], v8 offset:34016
    v_mfma_f32_16x16x32_bf16 v[24:27], a[124:127], v[188:191], v[24:27]
    ds_read_b64_tr_b16 a[254:255], v8 offset:50912
    v_mfma_f32_16x16x32_bf16 v[20:23], a[0:3], v[192:195], 0
    ds_read_b128 v[216:219], v47 offset:17280
    v_mfma_f32_16x16x32_bf16 v[28:31], a[64:67], v[192:195], 0
    v_mfma_f32_16x16x32_bf16 v[20:23], a[4:7], v[196:199], v[20:23]
    ds_read_b128 v[220:223], v47 offset:17344
    v_max3_f32 v32, v16, v17, v18
    s_nop 0
    v_max3_f32 v34, v19, v24, v25
    v_mfma_f32_16x16x32_bf16 v[28:31], a[68:71], v[196:199], v[28:31]
    v_max3_f32 v35, v26, v27, v32
    v_max_f32 v32, v34, v35
    s_waitcnt lgkmcnt(13)
    v_mfma_f32_16x16x32_bf16 v[20:23], a[8:11], v[200:203], v[20:23]
    ds_read_b128 v[224:227], v47 offset:17408
    ds_max_f32 v13, v32 offset:0
    v_mfma_f32_16x16x32_bf16 v[28:31], a[72:75], v[200:203], v[28:31]
    s_waitcnt lgkmcnt(12)
    v_mfma_f32_16x16x32_bf16 v[20:23], a[12:15], v[204:207], v[20:23]
    ds_read_b128 v[228:231], v47 offset:17472
    v_mfma_f32_16x16x32_bf16 v[28:31], a[76:79], v[204:207], v[28:31]
    s_waitcnt lgkmcnt(10)
    v_mfma_f32_16x16x32_bf16 v[20:23], a[16:19], v[208:211], v[20:23]
    ds_read_b128 v[232:235], v47 offset:17536
    s_waitcnt lgkmcnt(2)
    s_barrier
    ds_read_b32 v32, v13 offset:0
    v_mfma_f32_16x16x32_bf16 v[28:31], a[80:83], v[208:211], v[28:31]
    v_mfma_f32_16x16x32_bf16 v[20:23], a[20:23], v[212:215], v[20:23]
    ds_read_b128 v[236:239], v47 offset:17600
    v_mfma_f32_16x16x32_bf16 v[28:31], a[84:87], v[212:215], v[28:31]
    v_mfma_f32_16x16x32_bf16 v[20:23], a[24:27], v[216:219], v[20:23]
    ds_read_b128 v[240:243], v47 offset:17664
    v_mfma_f32_16x16x32_bf16 v[28:31], a[88:91], v[216:219], v[28:31]
    s_waitcnt lgkmcnt(2)
    v_sub_f32 v16, v16, v32
    v_sub_f32 v17, v17, v32
    v_mfma_f32_16x16x32_bf16 v[20:23], a[28:31], v[220:223], v[20:23]
    ds_read_b128 v[244:247], v47 offset:17728
    v_exp_f32 v16, v16
    v_sub_f32 v18, v18, v32
    v_mfma_f32_16x16x32_bf16 v[28:31], a[92:95], v[220:223], v[28:31]
    v_exp_f32 v17, v17
    v_sub_f32 v19, v19, v32
    v_mfma_f32_16x16x32_bf16 v[20:23], a[32:35], v[224:227], v[20:23]
    ds_read_b128 v[248:251], v47 offset:17792
    v_exp_f32 v18, v18
    v_sub_f32 v24, v24, v32
    v_mfma_f32_16x16x32_bf16 v[28:31], a[96:99], v[224:227], v[28:31]
    v_exp_f32 v19, v19
    v_sub_f32 v25, v25, v32
    v_mfma_f32_16x16x32_bf16 v[20:23], a[36:39], v[228:231], v[20:23]
    ds_read_b128 v[252:255], v47 offset:17856
    v_exp_f32 v24, v24
    v_sub_f32 v26, v26, v32
    v_mfma_f32_16x16x32_bf16 v[28:31], a[100:103], v[228:231], v[28:31]
    v_exp_f32 v25, v25
    v_sub_f32 v27, v27, v32
    v_mfma_f32_16x16x32_bf16 v[20:23], a[40:43], v[232:235], v[20:23]
    v_exp_f32 v26, v26
    v_mfma_f32_16x16x32_bf16 v[28:31], a[104:107], v[232:235], v[28:31]
    v_exp_f32 v27, v27
    s_waitcnt lgkmcnt(4)
    v_mfma_f32_16x16x32_bf16 v[20:23], a[44:47], v[236:239], v[20:23]
    v_cvt_pk_bf16_f32 v48, v16, v17
    v_cvt_pk_bf16_f32 v49, v18, v19
    v_mfma_f32_16x16x32_bf16 v[28:31], a[108:111], v[236:239], v[28:31]
    v_cvt_pk_bf16_f32 v50, v24, v25
    v_cvt_pk_bf16_f32 v51, v26, v27
    s_waitcnt lgkmcnt(3)
    v_mfma_f32_16x16x32_bf16 v[20:23], a[48:51], v[240:243], v[20:23]
    ds_write_b128 v14, v[48:51] offset:0
    v_mfma_f32_16x16x32_bf16 v[28:31], a[112:115], v[240:243], v[28:31]
    s_waitcnt lgkmcnt(3)
    v_mfma_f32_16x16x32_bf16 v[20:23], a[52:55], v[244:247], v[20:23]
    v_mfma_f32_16x16x32_bf16 v[28:31], a[116:119], v[244:247], v[28:31]
    s_waitcnt lgkmcnt(2)
    v_mfma_f32_16x16x32_bf16 v[20:23], a[56:59], v[248:251], v[20:23]
    s_waitcnt lgkmcnt(0)
    s_barrier
    ds_read_b128 v[128:131], v15 offset:0
    ds_read_b128 v[132:135], v15 offset:2048
    ds_read_b128 v[136:139], v15 offset:4096
    ds_read_b128 v[140:143], v15 offset:6144
    v_mfma_f32_16x16x32_bf16 v[28:31], a[120:123], v[248:251], v[28:31]
    v_mfma_f32_16x16x32_bf16 v[20:23], a[60:63], v[252:255], v[20:23]
    v_mfma_f32_16x16x32_bf16 v[28:31], a[124:127], v[252:255], v[28:31]
    s_waitcnt lgkmcnt(3)
    v_mfma_f32_16x16x32_bf16 v[64:67], v[128:131], a[128:131], 0
    v_mfma_f32_16x16x32_bf16 v[72:75], v[128:131], a[144:147], 0
    v_mfma_f32_16x16x32_bf16 v[80:83], v[128:131], a[160:163], 0
    s_nop 2
    v_max3_f32 v33, v20, v21, v22
    v_max3_f32 v34, v23, v28, v29
    v_mfma_f32_16x16x32_bf16 v[88:91], v[128:131], a[176:179], 0
    v_max3_f32 v35, v30, v31, v33
    v_max_f32 v33, v34, v35
    v_mfma_f32_16x16x32_bf16 v[96:99], v[128:131], a[192:195], 0
    ds_max_f32 v13, v33 offset:64
    v_mfma_f32_16x16x32_bf16 v[104:107], v[128:131], a[208:211], 0
    v_mfma_f32_16x16x32_bf16 v[112:115], v[128:131], a[224:227], 0
    v_mfma_f32_16x16x32_bf16 v[120:123], v[128:131], a[240:243], 0
    s_waitcnt lgkmcnt(3)
    v_mfma_f32_16x16x32_bf16 v[64:67], v[132:135], a[132:135], v[64:67]
    s_waitcnt lgkmcnt(0)
    s_barrier
    ds_read_b32 v33, v13 offset:64
    v_mfma_f32_16x16x32_bf16 v[72:75], v[132:135], a[148:151], v[72:75]
    v_mfma_f32_16x16x32_bf16 v[80:83], v[132:135], a[164:167], v[80:83]
    v_mfma_f32_16x16x32_bf16 v[88:91], v[132:135], a[180:183], v[88:91]
    v_mfma_f32_16x16x32_bf16 v[96:99], v[132:135], a[196:199], v[96:99]
    v_mfma_f32_16x16x32_bf16 v[104:107], v[132:135], a[212:215], v[104:107]
    s_waitcnt lgkmcnt(0)
    v_sub_f32 v20, v20, v33
    v_sub_f32 v21, v21, v33
    v_mfma_f32_16x16x32_bf16 v[112:115], v[132:135], a[228:231], v[112:115]
    v_exp_f32 v20, v20
    v_sub_f32 v22, v22, v33
    v_mfma_f32_16x16x32_bf16 v[120:123], v[132:135], a[244:247], v[120:123]
    v_exp_f32 v21, v21
    v_sub_f32 v23, v23, v33
    v_mfma_f32_16x16x32_bf16 v[64:67], v[136:139], a[136:139], v[64:67]
    v_exp_f32 v22, v22
    v_sub_f32 v28, v28, v33
    v_mfma_f32_16x16x32_bf16 v[72:75], v[136:139], a[152:155], v[72:75]
    v_exp_f32 v23, v23
    v_sub_f32 v29, v29, v33
    v_mfma_f32_16x16x32_bf16 v[80:83], v[136:139], a[168:171], v[80:83]
    v_exp_f32 v28, v28
    v_sub_f32 v30, v30, v33
    v_mfma_f32_16x16x32_bf16 v[88:91], v[136:139], a[184:187], v[88:91]
    v_exp_f32 v29, v29
    v_sub_f32 v31, v31, v33
    v_mfma_f32_16x16x32_bf16 v[96:99], v[136:139], a[200:203], v[96:99]
    v_exp_f32 v30, v30
    v_mfma_f32_16x16x32_bf16 v[104:107], v[136:139], a[216:219], v[104:107]
    v_exp_f32 v31, v31
    v_mfma_f32_16x16x32_bf16 v[112:115], v[136:139], a[232:235], v[112:115]
    v_cvt_pk_bf16_f32 v48, v20, v21
    v_cvt_pk_bf16_f32 v49, v22, v23
    v_mfma_f32_16x16x32_bf16 v[120:123], v[136:139], a[248:251], v[120:123]
    v_cvt_pk_bf16_f32 v50, v28, v29
    v_cvt_pk_bf16_f32 v51, v30, v31
    v_mfma_f32_16x16x32_bf16 v[64:67], v[140:143], a[140:143], v[64:67]
    ds_write_b128 v14, v[48:51] offset:1024
    v_mfma_f32_16x16x32_bf16 v[72:75], v[140:143], a[156:159], v[72:75]
    v_mfma_f32_16x16x32_bf16 v[80:83], v[140:143], a[172:175], v[80:83]
    v_mfma_f32_16x16x32_bf16 v[88:91], v[140:143], a[188:191], v[88:91]
    v_mfma_f32_16x16x32_bf16 v[96:99], v[140:143], a[204:207], v[96:99]
    s_waitcnt lgkmcnt(0)
    s_barrier
    ds_read_b128 v[144:147], v15 offset:1024
    ds_read_b128 v[148:151], v15 offset:3072
    ds_read_b128 v[152:155], v15 offset:5120
    ds_read_b128 v[156:159], v15 offset:7168
    v_mfma_f32_16x16x32_bf16 v[104:107], v[140:143], a[220:223], v[104:107]
    s_cmp_lg_u32 s3, 0
    s_cbranch_scc1 L_a_nosa0
    v_mfma_f32_16x16x32_bf16 v[52:55], v[40:43], v[128:131], 0
    v_mfma_f32_16x16x32_bf16 v[52:55], v[40:43], v[132:135], v[52:55]
    v_mfma_f32_16x16x32_bf16 v[52:55], v[40:43], v[136:139], v[52:55]
    v_mfma_f32_16x16x32_bf16 v[52:55], v[40:43], v[140:143], v[52:55]
L_a_nosa0:
    v_mfma_f32_16x16x32_bf16 v[112:115], v[140:143], a[236:239], v[112:115]
    v_mfma_f32_16x16x32_bf16 v[120:123], v[140:143], a[252:255], v[120:123]
    s_waitcnt lgkmcnt(3)
    v_mfma_f32_16x16x32_bf16 v[68:71], v[144:147], a[128:131], 0
    s_cmp_lg_u32 s3, 0
    s_cbranch_scc1 L_a_nost0
    v_mov_b32 v56, v32
    s_nop 0
    v_mov_b32 v57, v52
    s_mov_b64 exec, 0xffff
    buffer_store_dwordx4 v[56:59], v10, s[36:39], s57 offen sc1
    s_mov_b64 exec, -1
L_a_nost0:
    v_mfma_f32_16x16x32_bf16 v[76:79], v[144:147], a[144:147], 0
    v_cvt_pk_bf16_f32 v192, v64, v72
    v_cvt_pk_bf16_f32 v193, v80, v88
    s_waitcnt lgkmcnt(0)
    s_cmp_lg_u32 s3, 1
    s_cbranch_scc1 L_a_nosa1
    v_mfma_f32_16x16x32_bf16 v[52:55], v[40:43], v[144:147], 0
    v_mfma_f32_16x16x32_bf16 v[52:55], v[40:43], v[148:151], v[52:55]
    v_mfma_f32_16x16x32_bf16 v[52:55], v[40:43], v[152:155], v[52:55]
    v_mfma_f32_16x16x32_bf16 v[52:55], v[40:43], v[156:159], v[52:55]
L_a_nosa1:
    s_waitcnt lgkmcnt(2)
    v_mfma_f32_16x16x32_bf16 v[68:71], v[148:151], a[132:135], v[68:71]
    v_cvt_pk_bf16_f32 v194, v96, v104
    v_cvt_pk_bf16_f32 v195, v112, v120
    v_mfma_f32_16x16x32_bf16 v[76:79], v[148:151], a[148:151], v[76:79]
    v_and_or_b32 v192, v192, v4, s99
    v_and_or_b32 v193, v193, v4, s100
    s_waitcnt lgkmcnt(1)
    v_mfma_f32_16x16x32_bf16 v[68:71], v[152:155], a[136:139], v[68:71]
    v_and_or_b32 v194, v194, v4, s101
    v_and_or_b32 v195, v195, v4, s31
    s_cmp_lg_u32 s3, 1
    s_cbranch_scc1 L_a_nost1
    v_mov_b32 v56, v33
    v_mov_b32 v57, v52
    s_mov_b64 exec, 0xffff
    buffer_store_dwordx4 v[56:59], v10, s[36:39], s57 offen sc1
    s_mov_b64 exec, -1
L_a_nost1:
    v_mfma_f32_16x16x32_bf16 v[76:79], v[152:155], a[152:155], v[76:79]
    s_add_u32 s59, s58, 0
    buffer_store_dwordx4 v[192:195], v46, s[36:39], s59 offen sc1
    s_waitcnt lgkmcnt(0)
    v_mfma_f32_16x16x32_bf16 v[68:71], v[156:159], a[140:143], v[68:71]
    v_cvt_pk_bf16_f32 v196, v65, v73
    v_cvt_pk_bf16_f32 v197, v81, v89
    v_mfma_f32_16x16x32_bf16 v[76:79], v[156:159], a[156:159], v[76:79]
    v_cvt_pk_bf16_f32 v198, v97, v105
    v_cvt_pk_bf16_f32 v199, v113, v121
    v_mfma_f32_16x16x32_bf16 v[84:87], v[144:147], a[160:163], 0
    v_and_or_b32 v196, v196, v4, s99
    v_and_or_b32 v197, v197, v4, s100
    v_mfma_f32_16x16x32_bf16 v[92:95], v[144:147], a[176:179], 0
    v_and_or_b32 v198, v198, v4, s101
    v_and_or_b32 v199, v199, v4, s31
    v_mfma_f32_16x16x32_bf16 v[84:87], v[148:151], a[164:167], v[84:87]
    s_add_u32 s59, s58, 131584
    buffer_store_dwordx4 v[196:199], v46, s[36:39], s59 offen sc1
    v_mfma_f32_16x16x32_bf16 v[92:95], v[148:151], a[180:183], v[92:95]
    v_cvt_pk_bf16_f32 v200, v66, v74
    v_cvt_pk_bf16_f32 v201, v82, v90
    v_mfma_f32_16x16x32_bf16 v[84:87], v[152:155], a[168:171], v[84:87]
    v_cvt_pk_bf16_f32 v202, v98, v106
    v_cvt_pk_bf16_f32 v203, v114, v122
    v_mfma_f32_16x16x32_bf16 v[92:95], v[152:155], a[184:187], v[92:95]
    v_and_or_b32 v200, v200, v4, s99
    v_and_or_b32 v201, v201, v4, s100
    v_mfma_f32_16x16x32_bf16 v[84:87], v[156:159], a[172:175], v[84:87]
    v_and_or_b32 v202, v202, v4, s101
    v_and_or_b32 v203, v203, v4, s31
    v_mfma_f32_16x16x32_bf16 v[92:95], v[156:159], a[188:191], v[92:95]
    s_add_u32 s59, s58, 263168
    buffer_store_dwordx4 v[200:203], v46, s[36:39], s59 offen sc1
    s_cmp_lg_u32 s3, 3
    s_cbranch_scc1 L_a_noh1
    s_mov_b64 exec, 0xff
    buffer_store_dword v39, v38, s[36:39], s56 offen sc1
    s_mov_b64 exec, -1
L_a_noh1:
    v_mfma_f32_16x16x32_bf16 v[100:103], v[144:147], a[192:195], 0
    v_cvt_pk_bf16_f32 v204, v67, v75
    v_cvt_pk_bf16_f32 v205, v83, v91
    v_mfma_f32_16x16x32_bf16 v[108:111], v[144:147], a[208:211], 0
    v_cvt_pk_bf16_f32 v206, v99, v107
    v_cvt_pk_bf16_f32 v207, v115, v123
    v_mfma_f32_16x16x32_bf16 v[100:103], v[148:151], a[196:199], v[100:103]
    v_and_or_b32 v204, v204, v4, s99
    v_and_or_b32 v205, v205, v4, s100
    v_mfma_f32_16x16x32_bf16 v[108:111], v[148:151], a[212:215], v[108:111]
    v_and_or_b32 v206, v206, v4, s101
    v_and_or_b32 v207, v207, v4, s31
    v_mfma_f32_16x16x32_bf16 v[100:103], v[152:155], a[200:203], v[100:103]
    s_add_u32 s59, s58, 394752
    buffer_store_dwordx4 v[204:207], v46, s[36:39], s59 offen sc1
    v_mfma_f32_16x16x32_bf16 v[108:111], v[152:155], a[216:219], v[108:111]
    v_cvt_pk_bf16_f32 v208, v68, v76
    v_cvt_pk_bf16_f32 v212, v69, v77
    v_mfma_f32_16x16x32_bf16 v[100:103], v[156:159], a[204:207], v[100:103]
    v_and_or_b32 v208, v208, v4, s99
    v_and_or_b32 v212, v212, v4, s99
    v_mfma_f32_16x16x32_bf16 v[108:111], v[156:159], a[220:223], v[108:111]
    v_cvt_pk_bf16_f32 v216, v70, v78
    v_cvt_pk_bf16_f32 v220, v71, v79
    v_mfma_f32_16x16x32_bf16 v[116:119], v[144:147], a[224:227], 0
    v_and_or_b32 v216, v216, v4, s99
    v_and_or_b32 v220, v220, v4, s99
    v_mfma_f32_16x16x32_bf16 v[124:127], v[144:147], a[240:243], 0
    v_cvt_pk_bf16_f32 v209, v84, v92
    v_cvt_pk_bf16_f32 v213, v85, v93
    v_mfma_f32_16x16x32_bf16 v[116:119], v[148:151], a[228:231], v[116:119]
    v_and_or_b32 v209, v209, v4, s100
    v_and_or_b32 v213, v213, v4, s100
    v_mfma_f32_16x16x32_bf16 v[124:127], v[148:151], a[244:247], v[124:127]
    v_cvt_pk_bf16_f32 v217, v86, v94
    v_cvt_pk_bf16_f32 v221, v87, v95
    v_mfma_f32_16x16x32_bf16 v[116:119], v[152:155], a[232:235], v[116:119]
    v_and_or_b32 v217, v217, v4, s100
    v_and_or_b32 v221, v221, v4, s100
    v_mfma_f32_16x16x32_bf16 v[124:127], v[152:155], a[248:251], v[124:127]
    v_cvt_pk_bf16_f32 v210, v100, v108
    v_cvt_pk_bf16_f32 v214, v101, v109
    v_mfma_f32_16x16x32_bf16 v[116:119], v[156:159], a[236:239], v[116:119]
    v_and_or_b32 v210, v210, v4, s101
    v_and_or_b32 v214, v214, v4, s101
    v_mfma_f32_16x16x32_bf16 v[124:127], v[156:159], a[252:255], v[124:127]
    v_cvt_pk_bf16_f32 v218, v102, v110
    v_cvt_pk_bf16_f32 v222, v103, v111
    v_and_or_b32 v218, v218, v4, s101
    v_and_or_b32 v222, v222, v4, s101
    s_nop 3
    v_cvt_pk_bf16_f32 v211, v116, v124
    v_cvt_pk_bf16_f32 v215, v117, v125
    v_cvt_pk_bf16_f32 v219, v118, v126
    v_cvt_pk_bf16_f32 v223, v119, v127
    v_and_or_b32 v211, v211, v4, s31
    s_add_u32 s59, s58, 2105344
    buffer_store_dwordx4 v[208:211], v46, s[36:39], s59 offen sc1
    v_and_or_b32 v215, v215, v4, s31
    s_add_u32 s59, s58, 2236928
    buffer_store_dwordx4 v[212:215], v46, s[36:39], s59 offen sc1
    v_and_or_b32 v219, v219, v4, s31
    s_add_u32 s59, s58, 2368512
    buffer_store_dwordx4 v[216:219], v46, s[36:39], s59 offen sc1
    v_and_or_b32 v223, v223, v4, s31
    s_add_u32 s59, s58, 2500096
    buffer_store_dwordx4 v[220:223], v46, s[36:39], s59 offen sc1
    s_cmp_ge_u32 s54, 112
    s_cbranch_scc1 L_a_nofd0
    s_add_u32 m0, s30, 0
    s_add_u32 s59, s53, 0
    buffer_load_dwordx4 v60, s[40:43], s59 offen  lds
    s_add_u32 m0, s30, 1024
    s_add_u32 s59, s53, 114688
    buffer_load_dwordx4 v60, s[40:43], s59 offen  lds
    s_add_u32 m0, s30, 2048
    s_add_u32 s59, s53, 229376
    buffer_load_dwordx4 v60, s[40:43], s59 offen  lds
    s_add_u32 m0, s30, 3072
    s_add_u32 s59, s53, 344064
    buffer_load_dwordx4 v60, s[40:43], s59 offen  lds
    s_add_u32 m0, s30, 4096
    s_add_u32 s59, s52, 0
    buffer_load_dwordx4 v61, s[44:47], s59 offen  lds
    s_add_u32 m0, s30, 5120
    s_add_u32 s59, s52, 4096
    buffer_load_dwordx4 v62, s[44:47], s59 offen  lds
    s_add_u32 m0, s30, 6144
    s_add_u32 s59, s52, 8192
    buffer_load_dwordx4 v61, s[44:47], s59 offen  lds
    s_add_u32 m0, s30, 7168
    s_add_u32 s59, s52, 12288
    buffer_load_dwordx4 v62, s[44:47], s59 offen  lds
L_a_nofd0:
    s_cmp_ge_u32 s54, 112
    s_cbranch_scc1 L_a_noffn
    s_mov_b32 s66, s30
    s_lshl_b32 s64, s3, 8
    s_add_u32 s64, s64, 143872
    v_bfe_u32 v12, v2, 2, 1
    v_lshlrev_b32 v12, 10, v12
    v_lshl_add_u32 v12, v3, 4, v12
    v_add_u32 v12, s64, v12
    ds_read_b128 v[128:131], v12 offset:0
    ds_read_b128 v[132:135], v12 offset:64
    ds_read_b128 v[136:139], v12 offset:128
    ds_read_b128 v[140:143], v12 offset:192
    v_lshrrev_b32 v13, 2, v2
    v_lshl_add_u32 v8, v3, 3, v13
    v_and_b32 v10, 3, v2
    v_lshlrev_b32 v6, 5, v8
    v_lshl_add_u32 v6, v10, 3, v6
    v_add_u32 v6, s66, v6
    v_and_b32 v16, 1, v3
    v_lshl_add_u32 v16, v16, 2, v13
    v_lshlrev_b32 v16, 1, v16
    v_lshrrev_b32 v17, 1, v10
    v_xor_b32 v16, v16, v17
    v_lshlrev_b32 v16, 4, v16
    v_and_b32 v17, 1, v10
    v_lshl_add_u32 v16, v17, 3, v16
    v_add_u32 v16, s66, v16
    v_lshl_add_u32 v13, v3, 2, v13
    v_lshl_add_u32 v112, v13, 8, v16
    s_lshl_b32 s58, s3, 10
    v_add_u32 v7, s58, v9
    v_and_b32 v10, 1, v3
    v_lshlrev_b32 v10, 18, v10
    v_lshrrev_b32 v11, 1, v3
    v_lshl_add_u32 v10, v11, 15, v10
    v_lshrrev_b32 v11, 3, v2
    v_lshl_add_u32 v10, v11, 14, v10
    v_and_b32 v11, 7, v2
    v_lshl_add_u32 v10, v11, 4, v10
    s_lshl_b32 s62, s3, 16
    s_lshl_b32 s58, s54, 7
    s_add_u32 s62, s62, s58
    s_add_u32 s62, s62, 1048576
    v_mov_b32 v11, 0xffffff00
    s_mov_b32 s59, 0xbfb8aa3b
    v_cmp_lt_u32 s[68:69], 1, v3
    v_xor_b32 v113, 32, v112
    v_xor_b32 v114, 64, v112
    v_xor_b32 v115, 96, v112
    v_xor_b32 v116, 128, v112
    v_xor_b32 v117, 160, v112
    v_xor_b32 v118, 192, v112
    v_xor_b32 v119, 224, v112
    s_waitcnt vmcnt(0)
    ds_read_b64_tr_b16 v[144:145], v6 offset:0
    ds_read_b64_tr_b16 v[146:147], v6 offset:128
    ds_read_b64_tr_b16 v[148:149], v6 offset:1024
    ds_read_b64_tr_b16 v[150:151], v6 offset:1152
    ds_read_b64_tr_b16 v[152:153], v6 offset:2048
    ds_read_b64_tr_b16 v[154:155], v6 offset:2176
    ds_read_b64_tr_b16 v[156:157], v6 offset:3072
    ds_read_b64_tr_b16 v[158:159], v6 offset:3200
    s_waitcnt lgkmcnt(6)
    v_mfma_f32_16x16x32_bf16 v[40:43], v[144:147], v[128:131], 0
    s_waitcnt lgkmcnt(4)
    v_mfma_f32_16x16x32_bf16 v[40:43], v[148:151], v[132:135], v[40:43]
    s_waitcnt lgkmcnt(2)
    v_mfma_f32_16x16x32_bf16 v[40:43], v[152:155], v[136:139], v[40:43]
    s_waitcnt lgkmcnt(0)
    v_mfma_f32_16x16x32_bf16 v[40:43], v[156:159], v[140:143], v[40:43]
    ds_read_b64_tr_b16 v[64:65], v112 offset:4096
    ds_read_b64_tr_b16 v[66:67], v113 offset:4096
    ds_read_b64_tr_b16 v[68:69], v114 offset:4096
    ds_read_b64_tr_b16 v[70:71], v115 offset:4096
    ds_read_b64_tr_b16 v[72:73], v116 offset:4096
    ds_read_b64_tr_b16 v[74:75], v117 offset:4096
    ds_read_b64_tr_b16 v[76:77], v118 offset:4096
    ds_read_b64_tr_b16 v[78:79], v119 offset:4096
    ds_write_b128 v7, v[40:43]
    s_waitcnt lgkmcnt(0)
    s_barrier
    ds_read_b128 v[40:43], v9 offset:0
    ds_read_b128 v[44:47], v9 offset:1024
    ds_read_b128 v[48:51], v9 offset:2048
    ds_read_b128 v[52:55], v9 offset:3072
    s_waitcnt lgkmcnt(0)
    v_add_f32 v40, v40, v44
    v_add_f32 v48, v48, v52
    v_add_f32 v41, v41, v45
    v_add_f32 v49, v49, v53
    v_add_f32 v42, v42, v46
    v_add_f32 v50, v50, v54
    v_add_f32 v43, v43, v47
    v_add_f32 v51, v51, v55
    v_add_f32 v16, v40, v48
    v_add_f32 v17, v41, v49
    v_add_f32 v18, v42, v50
    v_add_f32 v19, v43, v51
    v_cvt_pk_bf16_f32 v20, v16, v17
    v_cvt_pk_bf16_f32 v21, v18, v19
    v_lshlrev_b32 v16, 16, v20
    v_and_b32 v17, 0xffff0000, v20
    v_lshlrev_b32 v18, 16, v21
    v_and_b32 v19, 0xffff0000, v21
    v_mul_f32 v20, s59, v16
    v_mul_f32 v21, s59, v17
    v_mul_f32 v22, s59, v18
    v_mul_f32 v23, s59, v19
    v_exp_f32 v20, v20
    v_exp_f32 v21, v21
    v_exp_f32 v22, v22
    v_exp_f32 v23, v23
    v_add_f32 v20, 1.0, v20
    v_add_f32 v21, 1.0, v21
    v_add_f32 v22, 1.0, v22
    v_add_f32 v23, 1.0, v23
    v_rcp_f32 v20, v20
    v_rcp_f32 v21, v21
    v_rcp_f32 v22, v22
    v_rcp_f32 v23, v23
    v_mul_f32 v16, v16, v20
    v_mul_f32 v17, v17, v21
    v_mul_f32 v18, v18, v22
    v_mul_f32 v19, v19, v23
    v_cvt_pk_bf16_f32 v20, v16, v17
    v_cvt_pk_bf16_f32 v21, v18, v19
    s_nop 1
    v_mfma_f32_16x16x16_bf16 v[80:83], v[20:21], v[64:65], 0
    v_mfma_f32_16x16x16_bf16 v[84:87], v[20:21], v[66:67], 0
    v_mfma_f32_16x16x16_bf16 v[88:91], v[20:21], v[68:69], 0
    v_mfma_f32_16x16x16_bf16 v[92:95], v[20:21], v[70:71], 0
    v_mfma_f32_16x16x16_bf16 v[96:99], v[20:21], v[72:73], 0
    v_mfma_f32_16x16x16_bf16 v[100:103], v[20:21], v[74:75], 0
    v_mfma_f32_16x16x16_bf16 v[104:107], v[20:21], v[76:77], 0
    v_mfma_f32_16x16x16_bf16 v[108:111], v[20:21], v[78:79], 0
    s_nop 4
    v_cndmask_b32 v52, v80, v96, s[68:69]
    v_cndmask_b32 v53, v84, v100, s[68:69]
    v_cndmask_b32 v54, v88, v104, s[68:69]
    v_cndmask_b32 v55, v92, v108, s[68:69]
    v_and_or_b32 v52, v52, v11, s17
    v_and_or_b32 v53, v53, v11, s17
    v_and_or_b32 v54, v54, v11, s17
    v_and_or_b32 v55, v55, v11, s17
    buffer_store_dwordx4 v[52:55], v10, s[36:39], s62 offen sc1
L_a_noffn:
    s_endpgm
L_wgt:
    v_lshrrev_b32 v4, 3, v2
    v_lshlrev_b32 v4, 10, v4
    v_lshl_add_u32 v4, v3, 6, v4
    s_lshl_b32 s63, s3, 8
    s_add_u32 s56, s61, 0
    s_and_b32 s56, s56, 3
    s_lshl_b32 s56, s56, 4
    s_add_u32 s56, s56, s63
    s_add_u32 s57, s61, 1
    s_and_b32 s57, s57, 3
    s_lshl_b32 s57, s57, 4
    s_add_u32 s57, s57, s63
    s_add_u32 s58, s61, 2
    s_and_b32 s58, s58, 3
    s_lshl_b32 s58, s58, 4
    s_add_u32 s58, s58, s63
    s_add_u32 s59, s61, 3
    s_and_b32 s59, s59, 3
    s_lshl_b32 s59, s59, 4
    s_add_u32 s59, s59, s63
    s_mov_b32 s32, s4
    s_mov_b32 s33, s5
    s_mov_b32 s34, 2048
    s_mov_b32 s35, 0x20000
    s_mov_b32 s36, s28
    s_mov_b32 s37, s29
    s_mov_b32 s38, 268435456
    s_mov_b32 s39, 0x20000
    buffer_load_dwordx4 v[16:19], v4, s[32:35], s56 offen
    buffer_load_dwordx4 v[20:23], v4, s[32:35], s57 offen
    buffer_load_dwordx4 v[24:27], v4, s[32:35], s58 offen
    buffer_load_dwordx4 v[28:31], v4, s[32:35], s59 offen
    v_mul_u32_u24 v125, 1381632, v1
    v_add_u32 v125, 2129920, v125
    v_mov_b32 v126, 196608
    v_cmp_gt_u32 vcc, 4, v1
    s_nop 1
    v_cndmask_b32 v125, v126, v125, vcc
    buffer_load_dword v126, v125, s[36:39], 0 offen sc1
    s_mov_b64 exec, 1
    s_lshl_b32 s67, s61, 20
    s_mov_b32 s48, s12
    s_mov_b32 s49, s13
    s_mov_b32 s50, 4194304
    s_mov_b32 s51, 0x20000
    buffer_load_dword v127, off, s[48:51], s67
    s_lshl_b32 s67, s60, 17
    s_mov_b32 s48, s14
    s_mov_b32 s49, s15
    s_mov_b32 s50, 4194304
    s_mov_b32 s51, 0x20000
    buffer_load_dword v127, off, s[48:51], s67
    s_mov_b64 exec, -1
    s_lshl_b32 s62, s60, 2
    s_add_u32 s62, s62, s61
    v_lshlrev_b32 v6, 1, v3
    v_xor_b32 v6, v6, v2
    v_xor_b32 v7, 8, v6
    v_lshlrev_b32 v6, 4, v6
    v_lshlrev_b32 v7, 4, v7
    v_lshl_add_u32 v122, v3, 13, v6
    v_lshl_add_u32 v123, v3, 13, v7
    v_lshl_add_u32 v120, v3, 10, v6
    v_lshl_add_u32 v121, v3, 10, v7
    v_lshlrev_b32 v9, 4, v1
    s_lshl_b32 s54, s61, 20
    s_lshl_b32 s55, s3, 18
    s_add_u32 s54, s54, s55
    s_add_u32 s54, s54, s65
    s_lshl_b32 s55, s3, 15
    s_mov_b32 m0, s55
    s_mov_b32 s44, s10
    s_mov_b32 s45, s11
    s_mov_b32 s46, 4194304
    s_mov_b32 s47, 0x20000
    v_and_b32 v10, 1, v3
    v_lshlrev_b32 v10, 18, v10
    v_lshrrev_b32 v11, 1, v3
    v_lshl_add_u32 v10, v11, 15, v10
    v_lshrrev_b32 v11, 3, v2
    v_lshl_add_u32 v10, v11, 14, v10
    v_and_b32 v11, 7, v2
    v_lshl_add_u32 v100, v11, 4, v10
    s_lshl_b32 s52, s3, 16
    s_lshl_b32 s53, s62, 7
    s_add_u32 s52, s52, s53
    s_add_u32 s52, s52, 524288
    v_and_b32 v12, 1, v2
    v_cmp_eq_u32 vcc, 1, v12
    v_mov_b32 v7, 0x0c0c0100
    v_mov_b32 v8, 0x01000c0c
    v_cndmask_b32 v10, v7, v8, vcc
    v_mov_b32 v7, 0x0c0c0302
    v_mov_b32 v8, 0x03020c0c
    v_cndmask_b32 v11, v7, v8, vcc
    v_bfe_u32 v12, v2, 1, 2
    v_mov_b32 v7, 0x0c0c0c0c
    v_cmp_eq_u32 vcc, 0, v12
    s_nop 1
    v_cndmask_b32 v32, v7, v10, vcc
    v_cndmask_b32 v33, v7, v11, vcc
    v_cmp_eq_u32 vcc, 1, v12
    s_nop 1
    v_cndmask_b32 v34, v7, v10, vcc
    v_cndmask_b32 v35, v7, v11, vcc
    v_cmp_eq_u32 vcc, 2, v12
    s_nop 1
    v_cndmask_b32 v36, v7, v10, vcc
    v_cndmask_b32 v37, v7, v11, vcc
    v_cmp_eq_u32 vcc, 3, v12
    s_nop 1
    v_cndmask_b32 v38, v7, v10, vcc
    v_cndmask_b32 v39, v7, v11, vcc
    v_lshrrev_b32 v7, 3, v2
    s_lshl_b32 s63, s3, 1
    v_add_u32 v7, s63, v7
    v_mul_u32_u24 v7, 272, v7
    v_and_b32 v8, 7, v2
    v_lshl_add_u32 v7, v8, 1, v7
    v_lshl_add_u32 v7, v3, 6, v7
    v_add_u32 v7, 24576, v7
    v_mul_u32_u24 v8, 272, v8
    v_lshl_add_u32 v8, v3, 4, v8
    v_add_u32 v8, 24576, v8
    v_lshlrev_b32 v10, 15, v2
    v_lshl_add_u32 v10, v3, 4, v10
    s_lshl_b32 s56, s62, 8
    s_lshl_b32 s57, s3, 6
    s_add_u32 s56, s56, s57
    s_mov_b32 s57, 0x3e0293ee
    s_mov_b32 s68, 0x00030003
    s_mov_b32 s69, 0x00030003
    v_mov_b32 v101, 0xfffefffe
    v_mov_b32 v102, 0xffffff00
    v_lshrrev_b32 v11, 2, v2
    v_lshlrev_b32 v11, 3, v11
    v_and_b32 v12, 3, v2
    v_add_u32 v11, v11, v12
    v_lshlrev_b32 v11, 8, v11
    v_and_b32 v12, 7, v2
    v_lshlrev_b32 v12, 1, v12
    v_xor_b32 v12, v12, v3
    v_lshl_add_u32 v11, v12, 4, v11
    v_add_u32 v92, s55, v11
    v_xor_b32 v93, 64, v92
    v_xor_b32 v94, 0x80, v92
    v_xor_b32 v95, 0xc0, v92
    s_add_u32 s63, s64, s66
    buffer_load_dwordx4 a[32:35], v5, s[40:43], s63 offen
    s_add_u32 s66, s66, 8192
    s_and_b32 s66, s66, 0x3ffff
    s_add_u32 s63, s64, s66
    buffer_load_dwordx4 a[36:39], v5, s[40:43], s63 offen
    s_add_u32 s66, s66, 8192
    s_and_b32 s66, s66, 0x3ffff
    s_waitcnt vmcnt(4)
    v_readlane_b32 s16, v126, 8
    s_nop 0
    s_add_u32 s17, s16, 1
    s_and_b32 s17, s17, 0x3f
    s_andn2_b32 s99, 3, s17
    s_lshl_b32 s99, s99, 6
    s_or_b32 s17, s17, s99
    s_add_u32 s16, s16, 0x100
    s_andn2_b32 s16, s16, 0xff
    s_or_b32 s16, s16, s17
    s_bfe_u32 s67, s17, 0x10001
    s_lshl_b32 s67, s67, 16
    s_bfe_u32 s99, s17, 0x10000
    s_or_b32 s99, s99, s67
    s_bfe_u32 s67, s17, 0x10003
    s_lshl_b32 s67, s67, 16
    s_bfe_u32 s100, s17, 0x10002
    s_or_b32 s100, s100, s67
    s_bfe_u32 s67, s17, 0x10005
    s_lshl_b32 s67, s67, 16
    s_bfe_u32 s101, s17, 0x10004
    s_or_b32 s101, s101, s67
    s_bfe_u32 s67, s17, 0x10007
    s_lshl_b32 s67, s67, 16
    s_bfe_u32 s31, s17, 0x10006
    s_or_b32 s31, s31, s67
    s_add_u32 s63, s64, s66
    buffer_load_dwordx4 a[40:43], v5, s[40:43], s63 offen
    s_add_u32 s66, s66, 8192
    s_and_b32 s66, s66, 0x3ffff
    v_perm_b32 v128, v16, v16, v32
    v_perm_b32 v129, v16, v16, v34
    v_perm_b32 v130, v16, v16, v36
    v_perm_b32 v131, v16, v16, v38
    v_perm_b32 v132, v16, v16, v33
    v_perm_b32 v133, v16, v16, v35
    v_mfma_f32_16x16x32_bf16 v[72:75], a[0:3], v[128:131], 0
    s_add_u32 s63, s64, s66
    buffer_load_dwordx4 a[44:47], v5, s[40:43], s63 offen
    s_add_u32 s66, s66, 8192
    s_and_b32 s66, s66, 0x3ffff
    v_perm_b32 v134, v16, v16, v37
    v_perm_b32 v135, v16, v16, v39
    v_perm_b32 v136, v17, v17, v32
    v_perm_b32 v137, v17, v17, v34
    v_perm_b32 v138, v17, v17, v36
    v_perm_b32 v139, v17, v17, v38
    v_mfma_f32_16x16x32_bf16 v[72:75], a[4:7], v[132:135], v[72:75]
    s_add_u32 s63, s64, s66
    buffer_load_dwordx4 a[48:51], v5, s[40:43], s63 offen
    s_add_u32 s66, s66, 8192
    s_and_b32 s66, s66, 0x3ffff
    v_perm_b32 v140, v17, v17, v33
    v_perm_b32 v141, v17, v17, v35
    v_perm_b32 v142, v17, v17, v37
    v_perm_b32 v143, v17, v17, v39
    v_perm_b32 v144, v18, v18, v32
    v_perm_b32 v145, v18, v18, v34
    v_mfma_f32_16x16x32_bf16 v[72:75], a[8:11], v[136:139], v[72:75]
    s_add_u32 s63, s64, s66
    buffer_load_dwordx4 a[52:55], v5, s[40:43], s63 offen
    s_add_u32 s66, s66, 8192
    s_and_b32 s66, s66, 0x3ffff
    v_perm_b32 v146, v18, v18, v36
    v_perm_b32 v147, v18, v18, v38
    v_perm_b32 v148, v18, v18, v33
    v_perm_b32 v149, v18, v18, v35
    v_perm_b32 v150, v18, v18, v37
    v_perm_b32 v151, v18, v18, v39
    v_mfma_f32_16x16x32_bf16 v[72:75], a[12:15], v[140:143], v[72:75]
    s_add_u32 s63, s64, s66
    buffer_load_dwordx4 a[56:59], v5, s[40:43], s63 offen
    s_add_u32 s66, s66, 8192
    s_and_b32 s66, s66, 0x3ffff
    v_perm_b32 v152, v19, v19, v32
    v_perm_b32 v153, v19, v19, v34
    v_perm_b32 v154, v19, v19, v36
    v_perm_b32 v155, v19, v19, v38
    v_perm_b32 v156, v19, v19, v33
    v_perm_b32 v157, v19, v19, v35
    v_mfma_f32_16x16x32_bf16 v[72:75], a[16:19], v[144:147], v[72:75]
    s_add_u32 s63, s64, s66
    buffer_load_dwordx4 a[60:63], v5, s[40:43], s63 offen
    s_add_u32 s66, s66, 8192
    s_and_b32 s66, s66, 0x3ffff
    v_perm_b32 v158, v19, v19, v37
    v_perm_b32 v159, v19, v19, v39
    v_perm_b32 v160, v20, v20, v32
    v_perm_b32 v161, v20, v20, v34
    v_perm_b32 v162, v20, v20, v36
    v_perm_b32 v163, v20, v20, v38
    v_mfma_f32_16x16x32_bf16 v[72:75], a[20:23], v[148:151], v[72:75]
    s_add_u32 s63, s64, s66
    buffer_load_dwordx4 a[64:67], v5, s[40:43], s63 offen
    s_add_u32 s66, s66, 8192
    s_and_b32 s66, s66, 0x3ffff
    v_perm_b32 v164, v20, v20, v33
    v_perm_b32 v165, v20, v20, v35
    v_perm_b32 v166, v20, v20, v37
    v_perm_b32 v167, v20, v20, v39
    v_perm_b32 v168, v21, v21, v32
    v_perm_b32 v169, v21, v21, v34
    v_mfma_f32_16x16x32_bf16 v[72:75], a[24:27], v[152:155], v[72:75]
    s_add_u32 s63, s64, s66
    buffer_load_dwordx4 a[68:71], v5, s[40:43], s63 offen
    s_add_u32 s66, s66, 8192
    s_and_b32 s66, s66, 0x3ffff
    v_perm_b32 v170, v21, v21, v36
    v_perm_b32 v171, v21, v21, v38
    v_perm_b32 v172, v21, v21, v33
    v_perm_b32 v173, v21, v21, v35
    v_perm_b32 v174, v21, v21, v37
    v_perm_b32 v175, v21, v21, v39
    v_mfma_f32_16x16x32_bf16 v[72:75], a[28:31], v[156:159], v[72:75]
    s_add_u32 s63, s64, s66
    buffer_load_dwordx4 a[72:75], v5, s[40:43], s63 offen
    s_add_u32 s66, s66, 8192
    s_and_b32 s66, s66, 0x3ffff
    v_perm_b32 v176, v22, v22, v32
    v_perm_b32 v177, v22, v22, v34
    v_perm_b32 v178, v22, v22, v36
    v_perm_b32 v179, v22, v22, v38
    v_perm_b32 v180, v22, v22, v33
    v_perm_b32 v181, v22, v22, v35
    s_waitcnt vmcnt(10)
    v_mfma_f32_16x16x32_bf16 v[72:75], a[32:35], v[160:163], v[72:75]
    s_add_u32 s63, s64, s66
    buffer_load_dwordx4 a[76:79], v5, s[40:43], s63 offen
    s_add_u32 s66, s66, 8192
    s_and_b32 s66, s66, 0x3ffff
    v_perm_b32 v182, v22, v22, v37
    v_perm_b32 v183, v22, v22, v39
    v_perm_b32 v184, v23, v23, v32
    v_perm_b32 v185, v23, v23, v34
    v_perm_b32 v186, v23, v23, v36
    v_perm_b32 v187, v23, v23, v38
    s_waitcnt vmcnt(10)
    v_mfma_f32_16x16x32_bf16 v[72:75], a[36:39], v[164:167], v[72:75]
    s_add_u32 s63, s64, s66
    buffer_load_dwordx4 a[80:83], v5, s[40:43], s63 offen
    s_add_u32 s66, s66, 8192
    s_and_b32 s66, s66, 0x3ffff
    v_perm_b32 v188, v23, v23, v33
    v_perm_b32 v189, v23, v23, v35
    v_perm_b32 v190, v23, v23, v37
    v_perm_b32 v191, v23, v23, v39
    v_perm_b32 v192, v24, v24, v32
    v_perm_b32 v193, v24, v24, v34
    s_waitcnt vmcnt(10)
    v_mfma_f32_16x16x32_bf16 v[72:75], a[40:43], v[168:171], v[72:75]
    s_add_u32 s63, s64, s66
    buffer_load_dwordx4 a[84:87], v5, s[40:43], s63 offen
    s_add_u32 s66, s66, 8192
    s_and_b32 s66, s66, 0x3ffff
    v_perm_b32 v194, v24, v24, v36
    v_perm_b32 v195, v24, v24, v38
    v_perm_b32 v196, v24, v24, v33
    v_perm_b32 v197, v24, v24, v35
    v_perm_b32 v198, v24, v24, v37
    v_perm_b32 v199, v24, v24, v39
    s_waitcnt vmcnt(10)
    v_mfma_f32_16x16x32_bf16 v[72:75], a[44:47], v[172:175], v[72:75]
    s_add_u32 s63, s64, s66
    buffer_load_dwordx4 a[88:91], v5, s[40:43], s63 offen
    s_add_u32 s66, s66, 8192
    s_and_b32 s66, s66, 0x3ffff
    v_perm_b32 v200, v25, v25, v32
    v_perm_b32 v201, v25, v25, v34
    v_perm_b32 v202, v25, v25, v36
    v_perm_b32 v203, v25, v25, v38
    v_perm_b32 v204, v25, v25, v33
    v_perm_b32 v205, v25, v25, v35
    s_waitcnt vmcnt(10)
    v_mfma_f32_16x16x32_bf16 v[72:75], a[48:51], v[176:179], v[72:75]
    s_add_u32 s63, s64, s66
    buffer_load_dwordx4 a[92:95], v5, s[40:43], s63 offen
    s_add_u32 s66, s66, 8192
    s_and_b32 s66, s66, 0x3ffff
    v_perm_b32 v206, v25, v25, v37
    v_perm_b32 v207, v25, v25, v39
    v_perm_b32 v208, v26, v26, v32
    v_perm_b32 v209, v26, v26, v34
    v_perm_b32 v210, v26, v26, v36
    v_perm_b32 v211, v26, v26, v38
    s_waitcnt vmcnt(10)
    v_mfma_f32_16x16x32_bf16 v[72:75], a[52:55], v[180:183], v[72:75]
    s_add_u32 s63, s64, s66
    buffer_load_dwordx4 a[96:99], v5, s[40:43], s63 offen
    s_add_u32 s66, s66, 8192
    s_and_b32 s66, s66, 0x3ffff
    v_perm_b32 v212, v26, v26, v33
    v_perm_b32 v213, v26, v26, v35
    v_perm_b32 v214, v26, v26, v37
    v_perm_b32 v215, v26, v26, v39
    v_perm_b32 v216, v27, v27, v32
    v_perm_b32 v217, v27, v27, v34
    s_waitcnt vmcnt(10)
    v_mfma_f32_16x16x32_bf16 v[72:75], a[56:59], v[184:187], v[72:75]
    s_add_u32 s63, s64, s66
    buffer_load_dwordx4 a[100:103], v5, s[40:43], s63 offen
    s_add_u32 s66, s66, 8192
    s_and_b32 s66, s66, 0x3ffff
    v_perm_b32 v218, v27, v27, v36
    v_perm_b32 v219, v27, v27, v38
    v_perm_b32 v220, v27, v27, v33
    v_perm_b32 v221, v27, v27, v35
    v_perm_b32 v222, v27, v27, v37
    v_perm_b32 v223, v27, v27, v39
    s_waitcnt vmcnt(10)
    v_mfma_f32_16x16x32_bf16 v[72:75], a[60:63], v[188:191], v[72:75]
    s_add_u32 s63, s64, s66
    buffer_load_dwordx4 a[104:107], v5, s[40:43], s63 offen
    s_add_u32 s66, s66, 8192
    s_and_b32 s66, s66, 0x3ffff
    v_perm_b32 v224, v28, v28, v32
    v_perm_b32 v225, v28, v28, v34
    v_perm_b32 v226, v28, v28, v36
    v_perm_b32 v227, v28, v28, v38
    v_perm_b32 v228, v28, v28, v33
    v_perm_b32 v229, v28, v28, v35
    s_waitcnt vmcnt(10)
    v_mfma_f32_16x16x32_bf16 v[72:75], a[64:67], v[192:195], v[72:75]
    s_add_u32 s63, s64, s66
    buffer_load_dwordx4 a[108:111], v5, s[40:43], s63 offen
    s_add_u32 s66, s66, 8192
    s_and_b32 s66, s66, 0x3ffff
    v_perm_b32 v230, v28, v28, v37
    v_perm_b32 v231, v28, v28, v39
    v_perm_b32 v232, v29, v29, v32
    v_perm_b32 v233, v29, v29, v34
    v_perm_b32 v234, v29, v29, v36
    v_perm_b32 v235, v29, v29, v38
    s_waitcnt vmcnt(10)
    v_mfma_f32_16x16x32_bf16 v[72:75], a[68:71], v[196:199], v[72:75]
    s_add_u32 s63, s64, s66
    buffer_load_dwordx4 a[112:115], v5, s[40:43], s63 offen
    s_add_u32 s66, s66, 8192
    s_and_b32 s66, s66, 0x3ffff
    v_perm_b32 v236, v29, v29, v33
    v_perm_b32 v237, v29, v29, v35
    v_perm_b32 v238, v29, v29, v37
    v_perm_b32 v239, v29, v29, v39
    v_perm_b32 v240, v30, v30, v32
    v_perm_b32 v241, v30, v30, v34
    s_waitcnt vmcnt(10)
    v_mfma_f32_16x16x32_bf16 v[72:75], a[72:75], v[200:203], v[72:75]
    s_add_u32 s63, s64, s66
    buffer_load_dwordx4 a[116:119], v5, s[40:43], s63 offen
    s_add_u32 s66, s66, 8192
    s_and_b32 s66, s66, 0x3ffff
    v_perm_b32 v242, v30, v30, v36
    v_perm_b32 v243, v30, v30, v38
    v_perm_b32 v244, v30, v30, v33
    v_perm_b32 v245, v30, v30, v35
    v_perm_b32 v246, v30, v30, v37
    v_perm_b32 v247, v30, v30, v39
    s_waitcnt vmcnt(10)
    v_mfma_f32_16x16x32_bf16 v[72:75], a[76:79], v[204:207], v[72:75]
    s_add_u32 s63, s64, s66
    buffer_load_dwordx4 a[120:123], v5, s[40:43], s63 offen
    s_add_u32 s66, s66, 8192
    s_and_b32 s66, s66, 0x3ffff
    v_perm_b32 v248, v31, v31, v32
    v_perm_b32 v249, v31, v31, v34
    v_perm_b32 v250, v31, v31, v36
    v_perm_b32 v251, v31, v31, v38
    v_perm_b32 v252, v31, v31, v33
    v_perm_b32 v253, v31, v31, v35
    s_waitcnt vmcnt(10)
    v_mfma_f32_16x16x32_bf16 v[72:75], a[80:83], v[208:211], v[72:75]
    s_add_u32 s63, s64, s66
    buffer_load_dwordx4 a[124:127], v5, s[40:43], s63 offen
    s_add_u32 s66, s66, 8192
    s_and_b32 s66, s66, 0x3ffff
    buffer_load_dwordx4 v122, s[44:47], s54 offen  lds
    s_add_u32 m0, m0, 1024
    s_add_u32 s54, s54, 32768
    buffer_load_dwordx4 v122, s[44:47], s54 offen  lds
    s_add_u32 m0, m0, 1024
    s_add_u32 s54, s54, 32768
    buffer_load_dwordx4 v123, s[44:47], s54 offen  lds
    s_add_u32 m0, m0, 1024
    s_add_u32 s54, s54, 32768
    buffer_load_dwordx4 v123, s[44:47], s54 offen  lds
    s_add_u32 m0, m0, 1024
    s_add_u32 s54, s54, 32768
    buffer_load_dwordx4 v122, s[44:47], s54 offen  lds
    s_add_u32 m0, m0, 1024
    s_add_u32 s54, s54, 32768
    buffer_load_dwordx4 v122, s[44:47], s54 offen  lds
    s_add_u32 m0, m0, 1024
    s_add_u32 s54, s54, 32768
    buffer_load_dwordx4 v123, s[44:47], s54 offen  lds
    s_add_u32 m0, m0, 1024
    s_add_u32 s54, s54, 32768
    buffer_load_dwordx4 v123, s[44:47], s54 offen  lds
    s_add_u32 m0, m0, 1024
    s_add_u32 s54, s54, 32768
    v_perm_b32 v254, v31, v31, v37
    v_perm_b32 v255, v31, v31, v39
    s_waitcnt vmcnt(18)
    v_mfma_f32_16x16x32_bf16 v[72:75], a[84:87], v[212:215], v[72:75]
    s_mov_b32 s44, s14
    s_mov_b32 s45, s15
    s_mov_b32 s46, 4194304
    s_mov_b32 s47, 0x20000
    v_bfe_u32 v5, v1, 2, 3
    v_lshlrev_b32 v5, 17, v5
    v_lshrrev_b32 v6, 5, v1
    v_lshl_add_u32 v5, v6, 13, v5
    v_and_b32 v6, 3, v1
    v_lshl_add_u32 v5, v6, 4, v5
    s_mov_b32 s66, s55
    s_lshl_b32 s64, s3, 8
    v_bfe_u32 v4, v2, 2, 1
    v_lshlrev_b32 v12, 10, v4
    v_lshl_add_u32 v12, v3, 4, v12
    v_lshrrev_b32 v14, 1, v1
    v_lshlrev_b32 v124, 13, v14
    v_mul_u32_u24 v14, 3584, v14
    v_and_b32 v15, 1, v1
    v_lshl_add_u32 v14, v15, 4, v14
    v_lshl_add_u32 v124, v15, 7, v124
    v_and_b32 v15, 31, v1
    v_mul_u32_u24 v125, 3584, v15
    v_lshlrev_b32 v15, 7, v15
    v_lshlrev_b32 v126, 7, v1
    s_sub_u32 s54, s54, 262144
    s_and_b32 s55, s2, 7
    s_lshl_b32 s55, s55, 14
    s_lshr_b32 s58, s2, 3
    s_lshl_b32 s58, s58, 10
    s_add_u32 s55, s55, s58
    s_add_u32 s55, s55, 393216
    s_lshl_b32 s30, s60, 17
    s_add_u32 s30, s30, s64
    v_and_b32 v103, 7, v1
    v_lshlrev_b32 v103, 7, v103
    s_waitcnt vmcnt(17)
    v_mfma_f32_16x16x32_bf16 v[72:75], a[88:91], v[216:219], v[72:75]
    s_waitcnt vmcnt(16)
    v_mfma_f32_16x16x32_bf16 v[72:75], a[92:95], v[220:223], v[72:75]
    s_waitcnt vmcnt(15)
    v_mfma_f32_16x16x32_bf16 v[72:75], a[96:99], v[224:227], v[72:75]
    s_waitcnt vmcnt(14)
    v_mfma_f32_16x16x32_bf16 v[72:75], a[100:103], v[228:231], v[72:75]
    s_waitcnt vmcnt(13)
    v_mfma_f32_16x16x32_bf16 v[72:75], a[104:107], v[232:235], v[72:75]
    s_waitcnt vmcnt(12)
    v_mfma_f32_16x16x32_bf16 v[72:75], a[108:111], v[236:239], v[72:75]
    s_waitcnt vmcnt(11)
    v_mfma_f32_16x16x32_bf16 v[72:75], a[112:115], v[240:243], v[72:75]
    s_waitcnt vmcnt(10)
    v_mfma_f32_16x16x32_bf16 v[72:75], a[116:119], v[244:247], v[72:75]
    s_waitcnt vmcnt(9)
    v_mfma_f32_16x16x32_bf16 v[72:75], a[120:123], v[248:251], v[72:75]
    s_waitcnt vmcnt(8)
    v_mfma_f32_16x16x32_bf16 v[72:75], a[124:127], v[252:255], v[72:75]
    v_and_b32 v124, 7, v1
    v_lshlrev_b32 v124, 14, v124
    v_lshrrev_b32 v125, 3, v1
    v_lshl_add_u32 v124, v125, 12, v124
    s_lshl_b32 s58, s61, 10
    s_and_b32 s59, s2, 7
    s_lshl_b32 s59, s59, 7
    s_add_u32 s58, s58, s59
    v_add_u32 v124, s58, v124
    v_mov_b32 v125, s16
    s_mov_b32 s4, 1572864
    s_mov_b32 s5, 1703936
    v_cvt_pk_bf16_f32 v76, v72, v73
    v_cvt_pk_bf16_f32 v77, v74, v75
    ds_write_b16 v7, v76
    ds_write_b16_d16_hi v7, v76 offset:16
    ds_write_b16 v7, v77 offset:32
    ds_write_b16_d16_hi v7, v77 offset:48
    s_waitcnt vmcnt(0)
    ds_read_b128 v[40:43], v92 offset:0
    ds_read_b128 v[44:47], v93 offset:0
    ds_read_b128 v[48:51], v94 offset:0
    ds_read_b128 v[52:55], v95 offset:0
    ds_read_b128 v[56:59], v92 offset:1024
    ds_read_b128 v[60:63], v93 offset:1024
    ds_read_b128 v[64:67], v94 offset:1024
    ds_read_b128 v[68:71], v95 offset:1024
    s_waitcnt lgkmcnt(8)
    s_barrier
    ds_read_b128 v[84:87], v8 offset:0
    ds_read_b128 v[88:91], v8 offset:64
    ds_read_b128 v[92:95], v8 offset:128
    ds_read_b128 v[96:99], v8 offset:192
    s_waitcnt lgkmcnt(3)
    v_mfma_f32_16x16x32_bf16 v[76:79], v[40:43], v[84:87], 0
    v_mfma_f32_16x16x32_bf16 v[80:83], v[56:59], v[84:87], 0
    s_waitcnt lgkmcnt(2)
    v_mfma_f32_16x16x32_bf16 v[76:79], v[44:47], v[88:91], v[76:79]
    v_mfma_f32_16x16x32_bf16 v[80:83], v[60:63], v[88:91], v[80:83]
    s_waitcnt lgkmcnt(1)
    v_mfma_f32_16x16x32_bf16 v[76:79], v[48:51], v[92:95], v[76:79]
    v_mfma_f32_16x16x32_bf16 v[80:83], v[64:67], v[92:95], v[80:83]
    s_waitcnt lgkmcnt(0)
    v_mfma_f32_16x16x32_bf16 v[76:79], v[52:55], v[96:99], v[76:79]
    v_mfma_f32_16x16x32_bf16 v[80:83], v[68:71], v[96:99], v[80:83]
    s_nop 6
    v_add_f32_dpp v76, v76, v76 quad_perm:[2,3,0,1] row_mask:0xf bank_mask:0xf
    v_add_f32_dpp v77, v77, v77 quad_perm:[2,3,0,1] row_mask:0xf bank_mask:0xf
    v_add_f32_dpp v78, v78, v78 quad_perm:[2,3,0,1] row_mask:0xf bank_mask:0xf
    v_add_f32_dpp v79, v79, v79 quad_perm:[2,3,0,1] row_mask:0xf bank_mask:0xf
    v_add_f32_dpp v80, v80, v80 quad_perm:[2,3,0,1] row_mask:0xf bank_mask:0xf
    v_add_f32_dpp v81, v81, v81 quad_perm:[2,3,0,1] row_mask:0xf bank_mask:0xf
    v_add_f32_dpp v82, v82, v82 quad_perm:[2,3,0,1] row_mask:0xf bank_mask:0xf
    v_add_f32_dpp v83, v83, v83 quad_perm:[2,3,0,1] row_mask:0xf bank_mask:0xf
    v_add_f32_dpp v76, v76, v76 row_ror:4 row_mask:0xf bank_mask:0xf
    v_add_f32_dpp v77, v77, v77 row_ror:4 row_mask:0xf bank_mask:0xf
    v_add_f32_dpp v78, v78, v78 row_ror:4 row_mask:0xf bank_mask:0xf
    v_add_f32_dpp v79, v79, v79 row_ror:4 row_mask:0xf bank_mask:0xf
    v_add_f32_dpp v80, v80, v80 row_ror:4 row_mask:0xf bank_mask:0xf
    v_add_f32_dpp v81, v81, v81 row_ror:4 row_mask:0xf bank_mask:0xf
    v_add_f32_dpp v82, v82, v82 row_ror:4 row_mask:0xf bank_mask:0xf
    v_add_f32_dpp v83, v83, v83 row_ror:4 row_mask:0xf bank_mask:0xf
    v_mul_f32 v76, s57, v76
    v_mul_f32 v77, s57, v77
    v_mul_f32 v78, s57, v78
    v_mul_f32 v79, s57, v79
    v_mul_f32 v80, s57, v80
    v_mul_f32 v81, s57, v81
    v_mul_f32 v82, s57, v82
    v_mul_f32 v83, s57, v83
    v_add_u32 v76, 0x10000, v76
    v_add_u32 v77, 0x10000, v77
    v_add_u32 v78, 0x10000, v78
    v_add_u32 v79, 0x10000, v79
    v_add_u32 v80, 0x10000, v80
    v_add_u32 v81, 0x10000, v81
    v_add_u32 v82, 0x10000, v82
    v_add_u32 v83, 0x10000, v83
    s_mov_b32 s57, 0x07060302
    v_perm_b32 v84, v77, v76, s57
    v_perm_b32 v85, v79, v78, s57
    v_perm_b32 v86, v81, v80, s57
    v_perm_b32 v87, v83, v82, s57
    v_and_or_b32 v84, v84, v101, s99
    v_and_or_b32 v85, v85, v101, s100
    v_and_or_b32 v86, v86, v101, s101
    v_and_or_b32 v87, v87, v101, s31
    s_mov_b64 exec, s[68:69]
    buffer_store_dwordx4 v[84:87], v10, s[36:39], s56 offen sc1
    s_mov_b64 exec, -1
    s_barrier
    s_mov_b32 s40, s22
    s_mov_b32 s41, s23
    s_mov_b32 s42, 1024
    s_mov_b32 s43, 0x20000
    s_lshr_b32 s58, s62, 6
    s_lshl_b32 s58, s58, 10
    buffer_load_dwordx4 v[40:43], v9, s[32:35], s58 offen
    buffer_load_dwordx4 v[44:47], v9, s[40:43], 0 offen
    v_lshrrev_b32 v13, 2, v2
    v_lshl_add_u32 v8, v3, 3, v13
    v_and_b32 v10, 3, v2
    v_lshlrev_b32 v11, 6, v8
    v_lshl_add_u32 v11, v10, 3, v11
    s_lshl_b32 s58, s3, 13
    s_add_u32 s58, s58, 131072
    v_add_u32 v11, s58, v11
    v_and_b32 v16, 1, v3
    v_lshl_add_u32 v16, v16, 2, v13
    v_lshlrev_b32 v16, 1, v16
    v_lshrrev_b32 v17, 1, v10
    v_xor_b32 v16, v16, v17
    v_lshlrev_b32 v16, 4, v16
    v_and_b32 v17, 1, v10
    v_lshl_add_u32 v16, v17, 3, v16
    v_add_u32 v16, s66, v16
    v_lshl_add_u32 v104, v8, 8, v16
    v_xor_b32 v105, 32, v104
    v_xor_b32 v106, 64, v104
    v_xor_b32 v107, 96, v104
    v_xor_b32 v108, 128, v104
    v_xor_b32 v109, 160, v104
    v_xor_b32 v110, 192, v104
    v_xor_b32 v111, 224, v104
    v_lshlrev_b32 v72, 9, v1
    s_and_b32 s58, s3, 1
    s_lshl_b32 s58, s58, 7
    v_lshl_add_u32 v73, v3, 5, s58
    v_lshlrev_b32 v74, 4, v2
    v_lshl_add_u32 v74, v3, 11, v74
    s_mul_i32 s58, s3, 32832
    v_and_b32 v75, 7, v2
    v_lshlrev_b32 v75, 1, v75
    v_lshl_add_u32 v75, v3, 6, v75
    v_add_u32 v75, s58, v75
    v_mul_u32_u24 v8, 32832, v10
    v_lshl_add_u32 v8, v3, 4, v8
    v_bfe_u32 v10, v2, 1, 1
    v_lshlrev_b32 v10, 6, v10
    v_lshl_add_u32 v10, v3, 3, v10
    s_add_u32 s58, s66, 2048
    v_add_u32 v10, s58, v10
    v_lshlrev_b32 v16, 6, v4
    v_lshl_add_u32 v16, v3, 4, v16
    v_add_u32 v16, 2048, v16
    s_add_u32 s58, s61, 0
    s_and_b32 s58, s58, 3
    s_lshl_b32 s58, s58, 15
    v_add_u32 v24, s58, v16
    s_add_u32 s58, s61, 1
    s_and_b32 s58, s58, 3
    s_lshl_b32 s58, s58, 15
    v_add_u32 v25, s58, v16
    s_add_u32 s58, s61, 2
    s_and_b32 s58, s58, 3
    s_lshl_b32 s58, s58, 15
    v_add_u32 v26, s58, v16
    s_add_u32 s58, s61, 3
    s_and_b32 s58, s58, 3
    s_lshl_b32 s58, s58, 15
    v_add_u32 v27, s58, v16
    v_and_b32 v75, 1, v3
    v_lshlrev_b32 v75, 3, v75
    v_lshl_add_u32 v75, v2, 4, v75
    s_mul_i32 s58, s3, 32832
    v_add_u32 v75, s58, v75
    v_and_b32 v17, 1, v2
    v_lshlrev_b32 v16, 6, v4
    v_lshl_add_u32 v16, v17, 5, v16
    v_and_b32 v18, 1, v3
    v_lshl_add_u32 v16, v18, 4, v16
    v_add_u32 v16, 2048, v16
    v_cmp_eq_u32 vcc, 1, v17
    v_mov_b32 v18, 0x4444
    v_mov_b32 v19, 0xeeee
    v_cndmask_b32 v6, v18, v19, vcc
    v_lshrrev_b32 v17, 1, v3
    v_add_u32 v17, s61, v17
    v_and_b32 v18, 3, v17
    v_lshl_add_u32 v18, v18, 15, v16
    v_add_u32 v17, 2, v17
    v_and_b32 v17, 3, v17
    v_lshl_add_u32 v17, v17, 15, v16
    s_add_u32 s58, s66, 2304
    v_mov_b32 v7, s58
    v_cmp_gt_u32 vcc, 8, v2
    s_nop 1
    v_cndmask_b32 v24, v7, v18, vcc
    v_cndmask_b32 v25, v18, v7, vcc
    v_cndmask_b32 v26, v7, v17, vcc
    v_cndmask_b32 v27, v17, v7, vcc
    v_bfe_u32 v10, v2, 1, 1
    v_lshlrev_b32 v10, 6, v10
    v_lshl_add_u32 v10, v3, 2, v10
    s_add_u32 s58, s66, 2048
    v_add_u32 v10, s58, v10
    s_mov_b32 s40, s12
    s_mov_b32 s41, s13
    s_mov_b32 s42, 4194304
    s_mov_b32 s43, 0x20000
    s_lshl_b32 s63, s61, 20
    s_lshl_b32 s58, s3, 6
    s_add_u32 s63, s63, s58
    s_add_u32 s63, s63, s65
    s_lshl_b32 s58, s3, 13
    s_add_u32 m0, s58, 131072
    s_nop 0
    buffer_load_dwordx4 v5, s[40:43], s63 offen  lds
    s_add_u32 m0, m0, 1024
    s_add_u32 s63, s63, 16384
    buffer_load_dwordx4 v5, s[40:43], s63 offen  lds
    s_add_u32 m0, m0, 1024
    s_add_u32 s63, s63, 16384
    buffer_load_dwordx4 v5, s[40:43], s63 offen  lds
    s_add_u32 m0, m0, 1024
    s_add_u32 s63, s63, 16384
    buffer_load_dwordx4 v5, s[40:43], s63 offen  lds
    s_add_u32 m0, m0, 1024
    s_add_u32 s63, s63, 16384
    buffer_load_dwordx4 v5, s[40:43], s63 offen  lds
    s_add_u32 m0, m0, 1024
    s_add_u32 s63, s63, 16384
    buffer_load_dwordx4 v5, s[40:43], s63 offen  lds
    s_add_u32 m0, m0, 1024
    s_add_u32 s63, s63, 16384
    buffer_load_dwordx4 v5, s[40:43], s63 offen  lds
    s_add_u32 m0, m0, 1024
    s_add_u32 s63, s63, 16384
    buffer_load_dwordx4 v5, s[40:43], s63 offen  lds
    s_add_u32 m0, m0, 1024
    s_add_u32 s63, s63, 16384
    s_waitcnt lgkmcnt(0)
    s_add_u32 s63, s61, 0
    s_and_b32 s63, s63, 3
    s_lshl_b32 s63, s63, 15
    s_add_u32 s63, s63, s30
    s_add_u32 m0, s66, 0
    s_nop 0
    buffer_load_dwordx4 v120, s[44:47], s63 offen  lds
    s_add_u32 m0, m0, 1024
    s_add_u32 s63, s63, 4096
    buffer_load_dwordx4 v120, s[44:47], s63 offen  lds
    s_add_u32 m0, m0, 1024
    s_add_u32 s63, s63, 4096
    buffer_load_dwordx4 v121, s[44:47], s63 offen  lds
    s_add_u32 m0, m0, 1024
    s_add_u32 s63, s63, 4096
    buffer_load_dwordx4 v121, s[44:47], s63 offen  lds
    s_add_u32 m0, m0, 1024
    s_add_u32 s63, s63, 4096
    buffer_load_dwordx4 v120, s[44:47], s63 offen  lds
    s_add_u32 m0, m0, 1024
    s_add_u32 s63, s63, 4096
    buffer_load_dwordx4 v120, s[44:47], s63 offen  lds
    s_add_u32 m0, m0, 1024
    s_add_u32 s63, s63, 4096
    buffer_load_dwordx4 v121, s[44:47], s63 offen  lds
    s_add_u32 m0, m0, 1024
    s_add_u32 s63, s63, 4096
    buffer_load_dwordx4 v121, s[44:47], s63 offen  lds
    s_waitcnt vmcnt(16)
    v_lshlrev_b32 v48, 16, v40
    v_and_b32 v49, 0xffff0000, v40
    v_lshlrev_b32 v50, 16, v44
    v_and_b32 v51, 0xffff0000, v44
    v_mul_f32 v48, v48, v50
    v_mul_f32 v49, v49, v51
    v_cvt_pk_bf16_f32 v48, v48, v49
    v_lshlrev_b32 v49, 16, v48
    v_and_b32 v48, 0xffff0000, v48
    v_add_f32 v29, v48, v49
    v_lshlrev_b32 v48, 16, v41
    v_and_b32 v49, 0xffff0000, v41
    v_lshlrev_b32 v50, 16, v45
    v_and_b32 v51, 0xffff0000, v45
    v_mul_f32 v48, v48, v50
    v_mul_f32 v49, v49, v51
    v_cvt_pk_bf16_f32 v48, v48, v49
    v_lshlrev_b32 v49, 16, v48
    v_and_b32 v48, 0xffff0000, v48
    v_add_f32 v29, v29, v48
    v_add_f32 v29, v29, v49
    v_lshlrev_b32 v48, 16, v42
    v_and_b32 v49, 0xffff0000, v42
    v_lshlrev_b32 v50, 16, v46
    v_and_b32 v51, 0xffff0000, v46
    v_mul_f32 v48, v48, v50
    v_mul_f32 v49, v49, v51
    v_cvt_pk_bf16_f32 v48, v48, v49
    v_lshlrev_b32 v49, 16, v48
    v_and_b32 v48, 0xffff0000, v48
    v_add_f32 v29, v29, v48
    v_add_f32 v29, v29, v49
    v_lshlrev_b32 v48, 16, v43
    v_and_b32 v49, 0xffff0000, v43
    v_lshlrev_b32 v50, 16, v47
    v_and_b32 v51, 0xffff0000, v47
    v_mul_f32 v48, v48, v50
    v_mul_f32 v49, v49, v51
    v_cvt_pk_bf16_f32 v48, v48, v49
    v_lshlrev_b32 v49, 16, v48
    v_and_b32 v48, 0xffff0000, v48
    v_add_f32 v29, v29, v48
    v_add_f32 v29, v29, v49
    s_nop 1
    v_add_f32_dpp v29, v29, v29 row_ror:8 row_mask:0xf bank_mask:0xf
    s_nop 1
    v_add_f32_dpp v29, v29, v29 row_ror:4 row_mask:0xf bank_mask:0xf
    s_nop 1
    v_add_f32_dpp v29, v29, v29 row_ror:2 row_mask:0xf bank_mask:0xf
    s_nop 1
    v_add_f32_dpp v29, v29, v29 row_ror:1 row_mask:0xf bank_mask:0xf
    v_mov_b32 v30, v29
    s_nop 1
    v_permlane16_swap_b32 v29, v30
    v_add_f32 v29, v29, v30
    v_mov_b32 v30, v29
    s_nop 1
    v_permlane32_swap_b32 v29, v30
    v_add_f32 v29, v29, v30
    v_cvt_pk_bf16_f32 v29, v29, v29
    v_and_b32 v29, 0xffff0000, v29
    s_mov_b32 s58, 0xbfb8aa3b
    v_mul_f32 v29, s58, v29
    v_exp_f32 v29, v29
    s_nop 0
    v_add_f32 v29, 1.0, v29
    v_rcp_f32 v29, v29
    s_nop 0
    v_cvt_pk_bf16_f32 v29, v29, v29
    v_and_b32 v29, 0xffff0000, v29
    v_sub_f32 v30, 1.0, v29
    v_cvt_pk_bf16_f32 v30, v30, v30
    v_and_b32 v30, 0xffff0000, v30
    s_mov_b32 s26, 2048
    s_mov_b32 s27, 0x20000
    s_lshr_b32 s34, s62, 2
    s_lshl_b32 s32, s34, 14
    s_lshl_b32 s35, s61, 5
    s_add_u32 s32, s32, s35
    s_add_u32 s32, s32, 524288
    s_lshr_b32 s35, s34, 1
    s_lshl_b32 s35, s35, 7
    s_and_b32 s34, s34, 1
    s_lshl_b32 s34, s34, 4
    s_add_u32 s35, s35, s34
    s_lshl_b32 s33, s61, 2
    s_add_u32 s35, s35, s33
    v_lshrrev_b32 v13, 1, v1
    v_lshlrev_b32 v13, 7, v13
    v_and_b32 v14, 1, v1
    v_lshl_add_u32 v13, v14, 4, v13
    v_lshlrev_b32 v14, 1, v14
    v_lshl_add_u32 v14, v3, 5, v14
    v_cmp_gt_u32 vcc, 32, v1
    v_mov_b32 v12, 0x7fffffff
    s_nop 0
    v_cndmask_b32 v12, v12, v13, vcc
    s_waitcnt vmcnt(8)
    s_waitcnt lgkmcnt(0)
    ds_read_b64_tr_b16 a[128:129], v11 offset:0
    ds_read_b64_tr_b16 a[130:131], v11 offset:256
    ds_read_b64_tr_b16 a[132:133], v11 offset:2048
    ds_read_b64_tr_b16 a[134:135], v11 offset:2304
    ds_read_b64_tr_b16 a[136:137], v11 offset:4096
    ds_read_b64_tr_b16 a[138:139], v11 offset:4352
    ds_read_b64_tr_b16 a[140:141], v11 offset:6144
    ds_read_b64_tr_b16 a[142:143], v11 offset:6400
    ds_read_b64_tr_b16 a[144:145], v11 offset:32
    ds_read_b64_tr_b16 a[146:147], v11 offset:288
    ds_read_b64_tr_b16 a[148:149], v11 offset:2080
    ds_read_b64_tr_b16 a[150:151], v11 offset:2336
    s_waitcnt lgkmcnt(0)
    ds_read_b64_tr_b16 a[152:153], v11 offset:4128
    ds_read_b64_tr_b16 a[154:155], v11 offset:4384
    ds_read_b64_tr_b16 a[156:157], v11 offset:6176
    ds_read_b64_tr_b16 a[158:159], v11 offset:6432
    s_waitcnt lgkmcnt(0)
    s_add_u32 s63, s61, 1
    s_and_b32 s63, s63, 3
    s_lshl_b32 s63, s63, 15
    s_add_u32 s63, s63, s30
    s_add_u32 m0, s66, 8192
    s_nop 0
    buffer_load_dwordx4 v120, s[44:47], s63 offen  lds
    s_add_u32 m0, m0, 1024
    s_add_u32 s63, s63, 4096
    buffer_load_dwordx4 v120, s[44:47], s63 offen  lds
    s_add_u32 m0, m0, 1024
    s_add_u32 s63, s63, 4096
    buffer_load_dwordx4 v121, s[44:47], s63 offen  lds
    s_add_u32 m0, m0, 1024
    s_add_u32 s63, s63, 4096
    buffer_load_dwordx4 v121, s[44:47], s63 offen  lds
    s_add_u32 m0, m0, 1024
    s_add_u32 s63, s63, 4096
    buffer_load_dwordx4 v120, s[44:47], s63 offen  lds
    s_add_u32 m0, m0, 1024
    s_add_u32 s63, s63, 4096
    buffer_load_dwordx4 v120, s[44:47], s63 offen  lds
    s_add_u32 m0, m0, 1024
    s_add_u32 s63, s63, 4096
    buffer_load_dwordx4 v121, s[44:47], s63 offen  lds
    s_add_u32 m0, m0, 1024
    s_add_u32 s63, s63, 4096
    buffer_load_dwordx4 v121, s[44:47], s63 offen  lds
    s_add_u32 s63, s61, 2
    s_and_b32 s63, s63, 3
    s_lshl_b32 s63, s63, 15
    s_add_u32 s63, s63, s30
    s_add_u32 m0, s66, 16384
    s_nop 0
    buffer_load_dwordx4 v120, s[44:47], s63 offen  lds
    s_add_u32 m0, m0, 1024
    s_add_u32 s63, s63, 4096
    buffer_load_dwordx4 v120, s[44:47], s63 offen  lds
    s_add_u32 m0, m0, 1024
    s_add_u32 s63, s63, 4096
    buffer_load_dwordx4 v121, s[44:47], s63 offen  lds
    s_add_u32 m0, m0, 1024
    s_add_u32 s63, s63, 4096
    buffer_load_dwordx4 v121, s[44:47], s63 offen  lds
    s_add_u32 m0, m0, 1024
    s_add_u32 s63, s63, 4096
    buffer_load_dwordx4 v120, s[44:47], s63 offen  lds
    s_add_u32 m0, m0, 1024
    s_add_u32 s63, s63, 4096
    buffer_load_dwordx4 v120, s[44:47], s63 offen  lds
    s_add_u32 m0, m0, 1024
    s_add_u32 s63, s63, 4096
    buffer_load_dwordx4 v121, s[44:47], s63 offen  lds
    s_add_u32 m0, m0, 1024
    s_add_u32 s63, s63, 4096
    buffer_load_dwordx4 v121, s[44:47], s63 offen  lds
    s_add_u32 s63, s61, 3
    s_and_b32 s63, s63, 3
    s_lshl_b32 s63, s63, 15
    s_add_u32 s63, s63, s30
    s_add_u32 m0, s66, 24576
    s_nop 0
    buffer_load_dwordx4 v120, s[44:47], s63 offen  lds
    s_add_u32 m0, m0, 1024
    s_add_u32 s63, s63, 4096
    buffer_load_dwordx4 v120, s[44:47], s63 offen  lds
    s_add_u32 m0, m0, 1024
    s_add_u32 s63, s63, 4096
    buffer_load_dwordx4 v121, s[44:47], s63 offen  lds
    s_add_u32 m0, m0, 1024
    s_add_u32 s63, s63, 4096
    buffer_load_dwordx4 v121, s[44:47], s63 offen  lds
    s_add_u32 m0, m0, 1024
    s_add_u32 s63, s63, 4096
    buffer_load_dwordx4 v120, s[44:47], s63 offen  lds
    s_add_u32 m0, m0, 1024
    s_add_u32 s63, s63, 4096
    buffer_load_dwordx4 v120, s[44:47], s63 offen  lds
    s_add_u32 m0, m0, 1024
    s_add_u32 s63, s63, 4096
    buffer_load_dwordx4 v121, s[44:47], s63 offen  lds
    s_add_u32 m0, m0, 1024
    s_add_u32 s63, s63, 4096
    buffer_load_dwordx4 v121, s[44:47], s63 offen  lds
    s_waitcnt vmcnt(24)
    s_waitcnt lgkmcnt(0)
    ds_read_b64_tr_b16 a[0:1], v104 offset:0
    ds_read_b64_tr_b16 a[2:3], v104 offset:1024
    ds_read_b64_tr_b16 a[16:17], v105 offset:0
    ds_read_b64_tr_b16 a[18:19], v105 offset:1024
    ds_read_b64_tr_b16 a[32:33], v106 offset:0
    ds_read_b64_tr_b16 a[34:35], v106 offset:1024
    ds_read_b64_tr_b16 a[48:49], v107 offset:0
    ds_read_b64_tr_b16 a[50:51], v107 offset:1024
    s_waitcnt lgkmcnt(0)
    ds_read_b64_tr_b16 a[64:65], v108 offset:0
    ds_read_b64_tr_b16 a[66:67], v108 offset:1024
    ds_read_b64_tr_b16 a[80:81], v109 offset:0
    ds_read_b64_tr_b16 a[82:83], v109 offset:1024
    ds_read_b64_tr_b16 a[96:97], v110 offset:0
    ds_read_b64_tr_b16 a[98:99], v110 offset:1024
    ds_read_b64_tr_b16 a[112:113], v111 offset:0
    ds_read_b64_tr_b16 a[114:115], v111 offset:1024
    s_sub_u32 s54, s55, 131072
    buffer_load_dword v31, v103, s[36:39], s54 offen sc1
    s_waitcnt vmcnt(17)
    s_waitcnt lgkmcnt(0)
    ds_read_b64_tr_b16 a[4:5], v104 offset:8192
    ds_read_b64_tr_b16 a[6:7], v104 offset:9216
    ds_read_b64_tr_b16 a[20:21], v105 offset:8192
    ds_read_b64_tr_b16 a[22:23], v105 offset:9216
    ds_read_b64_tr_b16 a[36:37], v106 offset:8192
    ds_read_b64_tr_b16 a[38:39], v106 offset:9216
    ds_read_b64_tr_b16 a[52:53], v107 offset:8192
    ds_read_b64_tr_b16 a[54:55], v107 offset:9216
    s_waitcnt lgkmcnt(0)
    ds_read_b64_tr_b16 a[68:69], v108 offset:8192
    ds_read_b64_tr_b16 a[70:71], v108 offset:9216
    ds_read_b64_tr_b16 a[84:85], v109 offset:8192
    ds_read_b64_tr_b16 a[86:87], v109 offset:9216
    ds_read_b64_tr_b16 a[100:101], v110 offset:8192
    ds_read_b64_tr_b16 a[102:103], v110 offset:9216
    ds_read_b64_tr_b16 a[116:117], v111 offset:8192
    ds_read_b64_tr_b16 a[118:119], v111 offset:9216
    s_waitcnt vmcnt(9)
    s_waitcnt lgkmcnt(0)
    ds_read_b64_tr_b16 a[8:9], v104 offset:16384
    ds_read_b64_tr_b16 a[10:11], v104 offset:17408
    ds_read_b64_tr_b16 a[24:25], v105 offset:16384
    ds_read_b64_tr_b16 a[26:27], v105 offset:17408
    ds_read_b64_tr_b16 a[40:41], v106 offset:16384
    ds_read_b64_tr_b16 a[42:43], v106 offset:17408
    ds_read_b64_tr_b16 a[56:57], v107 offset:16384
    ds_read_b64_tr_b16 a[58:59], v107 offset:17408
    s_waitcnt lgkmcnt(0)
    ds_read_b64_tr_b16 a[72:73], v108 offset:16384
    ds_read_b64_tr_b16 a[74:75], v108 offset:17408
    ds_read_b64_tr_b16 a[88:89], v109 offset:16384
    ds_read_b64_tr_b16 a[90:91], v109 offset:17408
    ds_read_b64_tr_b16 a[104:105], v110 offset:16384
    ds_read_b64_tr_b16 a[106:107], v110 offset:17408
    ds_read_b64_tr_b16 a[120:121], v111 offset:16384
    ds_read_b64_tr_b16 a[122:123], v111 offset:17408
    s_waitcnt vmcnt(1)
    s_waitcnt lgkmcnt(0)
    ds_read_b64_tr_b16 a[12:13], v104 offset:24576
    ds_read_b64_tr_b16 a[14:15], v104 offset:25600
    ds_read_b64_tr_b16 a[28:29], v105 offset:24576
    ds_read_b64_tr_b16 a[30:31], v105 offset:25600
    ds_read_b64_tr_b16 a[44:45], v106 offset:24576
    ds_read_b64_tr_b16 a[46:47], v106 offset:25600
    ds_read_b64_tr_b16 a[60:61], v107 offset:24576
    ds_read_b64_tr_b16 a[62:63], v107 offset:25600
    s_waitcnt lgkmcnt(0)
    ds_read_b64_tr_b16 a[76:77], v108 offset:24576
    ds_read_b64_tr_b16 a[78:79], v108 offset:25600
    ds_read_b64_tr_b16 a[92:93], v109 offset:24576
    ds_read_b64_tr_b16 a[94:95], v109 offset:25600
    ds_read_b64_tr_b16 a[108:109], v110 offset:24576
    ds_read_b64_tr_b16 a[110:111], v110 offset:25600
    ds_read_b64_tr_b16 a[124:125], v111 offset:24576
    ds_read_b64_tr_b16 a[126:127], v111 offset:25600
    s_lshr_b32 s63, s3, 1
    s_lshl_b32 s63, s63, 15
    s_lshl_b32 s64, s60, 4
    s_add_u32 s63, s63, s64
    s_add_u32 s63, s63, 65536
    s_mul_i32 s64, s62, 32896
    s_lshl_b32 s66, s3, 13
    s_add_u32 s64, s64, s66
    s_add_u32 s64, s64, 2097152
    v_mov_b32 v15, s16
    s_mov_b32 s6, s55
    v_cmp_lt_u32 s[58:59], 1, v3
    s_waitcnt lgkmcnt(0)
    v_mov_b32 v192, 0
    v_mov_b32 v193, 0
    v_mov_b32 v194, 0
    v_mov_b32 v195, 0
    v_mov_b32 v196, 0
    v_mov_b32 v197, 0
    v_mov_b32 v198, 0
    v_mov_b32 v199, 0
    v_mov_b32 v200, 0
    v_mov_b32 v201, 0
    v_mov_b32 v202, 0
    v_mov_b32 v203, 0
    v_mov_b32 v204, 0
    v_mov_b32 v205, 0
    v_mov_b32 v206, 0
    v_mov_b32 v207, 0
    ds_write_b128 v7, v[192:195]
    s_waitcnt vmcnt(0)
    s_mov_b32 s67, 0
L_w_h1:
    v_cmp_ne_u32 vcc, s16, v31
    s_nop 0
    s_cbranch_vccz L_w_h1_ok
    s_add_u32 s67, s67, 1
    s_cmp_ge_u32 s67, 150000
    s_cbranch_scc1 L_w_h1_ok
    buffer_load_dword v31, v103, s[36:39], s54 offen sc1
    s_waitcnt vmcnt(0)
    s_branch L_w_h1
L_w_h1_ok:
    s_mov_b32 s67, 0
L_w_spoll:
    buffer_load_dwordx4 v[16:19], v72, s[36:39], s63 offen sc1
    s_add_u32 s67, s67, 1
    s_waitcnt vmcnt(0)
    v_cmp_ne_u32 vcc, s16, v18
    s_cmp_ge_u32 s67, 150000
    s_cbranch_scc1 L_w_sdone
    s_cbranch_vccnz L_w_spoll
L_w_sdone:
    buffer_load_dwordx4 v[160:163], v74, s[36:39], s64 offen offset:0 sc1
    buffer_load_dwordx4 v[164:167], v74, s[36:39], s64 offen offset:256 sc1
    buffer_load_dwordx4 v[168:171], v74, s[36:39], s64 offen offset:512 sc1
    buffer_load_dwordx4 v[172:175], v74, s[36:39], s64 offen offset:768 sc1
    buffer_load_dwordx4 v[176:179], v74, s[36:39], s64 offen offset:1024 sc1
    buffer_load_dwordx4 v[180:183], v74, s[36:39], s64 offen offset:1280 sc1
    buffer_load_dwordx4 v[184:187], v74, s[36:39], s64 offen offset:1536 sc1
    buffer_load_dwordx4 v[188:191], v74, s[36:39], s64 offen offset:1792 sc1
    v_mov_b32 v20, v16
    s_nop 1
    v_max_f32_dpp v20, v20, v20 row_ror:8 row_mask:0xf bank_mask:0xf
    s_nop 1
    v_max_f32_dpp v20, v20, v20 row_ror:4 row_mask:0xf bank_mask:0xf
    s_nop 1
    v_max_f32_dpp v20, v20, v20 row_ror:2 row_mask:0xf bank_mask:0xf
    s_nop 1
    v_max_f32_dpp v20, v20, v20 row_ror:1 row_mask:0xf bank_mask:0xf
    v_mov_b32 v21, v20
    s_nop 1
    v_permlane16_swap_b32 v20, v21
    v_max_f32 v20, v20, v21
    v_mov_b32 v21, v20
    s_nop 1
    v_permlane32_swap_b32 v20, v21
    v_max_f32 v20, v20, v21
    v_sub_f32 v20, v16, v20
    v_exp_f32 v22, v20
    s_nop 0
    v_mul_f32 v20, v22, v17
    s_nop 1
    v_add_f32_dpp v20, v20, v20 row_ror:8 row_mask:0xf bank_mask:0xf
    s_nop 1
    v_add_f32_dpp v20, v20, v20 row_ror:4 row_mask:0xf bank_mask:0xf
    s_nop 1
    v_add_f32_dpp v20, v20, v20 row_ror:2 row_mask:0xf bank_mask:0xf
    s_nop 1
    v_add_f32_dpp v20, v20, v20 row_ror:1 row_mask:0xf bank_mask:0xf
    v_mov_b32 v21, v20
    s_nop 1
    v_permlane16_swap_b32 v20, v21
    v_add_f32 v20, v20, v21
    v_mov_b32 v21, v20
    s_nop 1
    v_permlane32_swap_b32 v20, v21
    v_add_f32 v20, v20, v21
    v_mul_f32 v22, 0x3f805c55, v22
    v_rcp_f32 v20, v20
    s_nop 0
    v_mul_f32 v20, v20, v22
    v_cvt_pk_bf16_f32 v28, v20, v20
    ds_bpermute_b32 v40, v73, v28 offset:0
    ds_bpermute_b32 v41, v73, v28 offset:4
    ds_bpermute_b32 v42, v73, v28 offset:8
    ds_bpermute_b32 v43, v73, v28 offset:12
    ds_bpermute_b32 v44, v73, v28 offset:16
    ds_bpermute_b32 v45, v73, v28 offset:20
    ds_bpermute_b32 v46, v73, v28 offset:24
    ds_bpermute_b32 v47, v73, v28 offset:28
    s_waitcnt lgkmcnt(7)
    v_perm_b32 v128, v40, v40, v32
    v_perm_b32 v129, v40, v40, v34
    v_perm_b32 v130, v40, v40, v36
    v_perm_b32 v131, v40, v40, v38
    s_waitcnt lgkmcnt(6)
    v_perm_b32 v132, v41, v41, v32
    v_perm_b32 v133, v41, v41, v34
    v_perm_b32 v134, v41, v41, v36
    v_perm_b32 v135, v41, v41, v38
    s_waitcnt lgkmcnt(5)
    v_perm_b32 v136, v42, v42, v32
    v_perm_b32 v137, v42, v42, v34
    v_perm_b32 v138, v42, v42, v36
    v_perm_b32 v139, v42, v42, v38
    s_waitcnt lgkmcnt(4)
    v_perm_b32 v140, v43, v43, v32
    v_perm_b32 v141, v43, v43, v34
    v_perm_b32 v142, v43, v43, v36
    v_perm_b32 v143, v43, v43, v38
    s_waitcnt lgkmcnt(3)
    v_perm_b32 v144, v44, v44, v32
    v_perm_b32 v145, v44, v44, v34
    v_perm_b32 v146, v44, v44, v36
    v_perm_b32 v147, v44, v44, v38
    s_waitcnt lgkmcnt(2)
    v_perm_b32 v148, v45, v45, v32
    v_perm_b32 v149, v45, v45, v34
    v_perm_b32 v150, v45, v45, v36
    v_perm_b32 v151, v45, v45, v38
    s_waitcnt lgkmcnt(1)
    v_perm_b32 v152, v46, v46, v32
    v_perm_b32 v153, v46, v46, v34
    v_perm_b32 v154, v46, v46, v36
    v_perm_b32 v155, v46, v46, v38
    s_waitcnt lgkmcnt(0)
    v_perm_b32 v156, v47, v47, v32
    v_perm_b32 v157, v47, v47, v34
    v_perm_b32 v158, v47, v47, v36
    v_perm_b32 v159, v47, v47, v38
    s_mov_b32 s67, 0
L_w_bpoll:
    s_add_u32 s67, s67, 1
    s_waitcnt vmcnt(7)
    v_xor_b32 v160, s99, v160
    v_xor_b32 v161, s100, v161
    v_xor_b32 v162, s101, v162
    v_xor_b32 v163, s31, v163
    v_or3_b32 v21, v160, v161, v162
    v_or_b32 v21, v21, v163
    v_mfma_f32_16x16x32_bf16 v[48:51], v[128:131], v[160:163], 0
    s_waitcnt vmcnt(6)
    v_xor_b32 v164, s99, v164
    v_xor_b32 v165, s100, v165
    v_xor_b32 v166, s101, v166
    v_xor_b32 v167, s31, v167
    v_or3_b32 v21, v21, v164, v165
    v_or3_b32 v21, v21, v166, v167
    v_mfma_f32_16x16x32_bf16 v[48:51], v[132:135], v[164:167], v[48:51]
    s_waitcnt vmcnt(5)
    v_xor_b32 v168, s99, v168
    v_xor_b32 v169, s100, v169
    v_xor_b32 v170, s101, v170
    v_xor_b32 v171, s31, v171
    v_or3_b32 v21, v21, v168, v169
    v_or3_b32 v21, v21, v170, v171
    v_mfma_f32_16x16x32_bf16 v[48:51], v[136:139], v[168:171], v[48:51]
    s_waitcnt vmcnt(4)
    v_xor_b32 v172, s99, v172
    v_xor_b32 v173, s100, v173
    v_xor_b32 v174, s101, v174
    v_xor_b32 v175, s31, v175
    v_or3_b32 v21, v21, v172, v173
    v_or3_b32 v21, v21, v174, v175
    v_mfma_f32_16x16x32_bf16 v[48:51], v[140:143], v[172:175], v[48:51]
    s_waitcnt vmcnt(3)
    v_xor_b32 v176, s99, v176
    v_xor_b32 v177, s100, v177
    v_xor_b32 v178, s101, v178
    v_xor_b32 v179, s31, v179
    v_or3_b32 v21, v21, v176, v177
    v_or3_b32 v21, v21, v178, v179
    v_mfma_f32_16x16x32_bf16 v[48:51], v[144:147], v[176:179], v[48:51]
    s_waitcnt vmcnt(2)
    v_xor_b32 v180, s99, v180
    v_xor_b32 v181, s100, v181
    v_xor_b32 v182, s101, v182
    v_xor_b32 v183, s31, v183
    v_or3_b32 v21, v21, v180, v181
    v_or3_b32 v21, v21, v182, v183
    v_mfma_f32_16x16x32_bf16 v[48:51], v[148:151], v[180:183], v[48:51]
    s_waitcnt vmcnt(1)
    v_xor_b32 v184, s99, v184
    v_xor_b32 v185, s100, v185
    v_xor_b32 v186, s101, v186
    v_xor_b32 v187, s31, v187
    v_or3_b32 v21, v21, v184, v185
    v_or3_b32 v21, v21, v186, v187
    v_mfma_f32_16x16x32_bf16 v[48:51], v[152:155], v[184:187], v[48:51]
    s_waitcnt vmcnt(0)
    v_xor_b32 v188, s99, v188
    v_xor_b32 v189, s100, v189
    v_xor_b32 v190, s101, v190
    v_xor_b32 v191, s31, v191
    v_or3_b32 v21, v21, v188, v189
    v_or3_b32 v21, v21, v190, v191
    v_mfma_f32_16x16x32_bf16 v[48:51], v[156:159], v[188:191], v[48:51]
    v_and_b32 v21, 0x10001, v21
    v_cmp_ne_u32 vcc, 0, v21
    s_nop 0
    s_cbranch_vccz L_w_bdone
    s_cmp_ge_u32 s67, 150000
    s_cbranch_scc1 L_w_bdone
    buffer_load_dwordx4 v[160:163], v74, s[36:39], s64 offen offset:0 sc1
    buffer_load_dwordx4 v[164:167], v74, s[36:39], s64 offen offset:256 sc1
    buffer_load_dwordx4 v[168:171], v74, s[36:39], s64 offen offset:512 sc1
    buffer_load_dwordx4 v[172:175], v74, s[36:39], s64 offen offset:768 sc1
    buffer_load_dwordx4 v[176:179], v74, s[36:39], s64 offen offset:1024 sc1
    buffer_load_dwordx4 v[180:183], v74, s[36:39], s64 offen offset:1280 sc1
    buffer_load_dwordx4 v[184:187], v74, s[36:39], s64 offen offset:1536 sc1
    buffer_load_dwordx4 v[188:191], v74, s[36:39], s64 offen offset:1792 sc1
    s_branch L_w_bpoll
L_w_bdone:
    s_nop 3
    v_cvt_pk_bf16_f32 v52, v48, v49
    v_cvt_pk_bf16_f32 v53, v50, v51
    ds_write_b64 v75, v[52:53]
    s_waitcnt lgkmcnt(0)
    s_barrier
    ds_read_b128 v[84:87], v8 offset:0
    ds_read_b128 v[88:91], v8 offset:64
    ds_read_b128 v[92:95], v8 offset:128
    ds_read_b128 v[96:99], v8 offset:192
    s_lshl_b32 s7, s62, 2
    s_or_b32 s7, s7, s3
    s_cmp_lg_u32 s7, 6
    s_cbranch_scc1 L_w_noep
    s_mov_b32 s7, 196608
    s_mov_b64 exec, 1
    buffer_store_dword v15, off, s[36:39], s7 sc1
    s_mov_b64 exec, -1
L_w_noep:
    s_waitcnt lgkmcnt(3)
    v_mfma_f32_16x16x32_bf16 v[76:79], a[128:131], v[84:87], 0
    v_mfma_f32_16x16x32_bf16 v[80:83], a[144:147], v[84:87], 0
    s_waitcnt lgkmcnt(2)
    v_mfma_f32_16x16x32_bf16 v[76:79], a[132:135], v[88:91], v[76:79]
    v_mfma_f32_16x16x32_bf16 v[80:83], a[148:151], v[88:91], v[80:83]
    s_waitcnt lgkmcnt(1)
    v_mfma_f32_16x16x32_bf16 v[76:79], a[136:139], v[92:95], v[76:79]
    v_mfma_f32_16x16x32_bf16 v[80:83], a[152:155], v[92:95], v[80:83]
    s_waitcnt lgkmcnt(0)
    v_mfma_f32_16x16x32_bf16 v[76:79], a[140:143], v[96:99], v[76:79]
    v_mfma_f32_16x16x32_bf16 v[80:83], a[156:159], v[96:99], v[80:83]
    s_nop 6
    v_add_f32_dpp v76, v76, v76 quad_perm:[1,0,3,2] row_mask:0xf bank_mask:0xf
    v_add_f32_dpp v77, v77, v77 quad_perm:[1,0,3,2] row_mask:0xf bank_mask:0xf
    v_add_f32_dpp v78, v78, v78 quad_perm:[1,0,3,2] row_mask:0xf bank_mask:0xf
    v_add_f32_dpp v79, v79, v79 quad_perm:[1,0,3,2] row_mask:0xf bank_mask:0xf
    v_add_f32_dpp v80, v80, v80 quad_perm:[1,0,3,2] row_mask:0xf bank_mask:0xf
    v_add_f32_dpp v81, v81, v81 quad_perm:[1,0,3,2] row_mask:0xf bank_mask:0xf
    v_add_f32_dpp v82, v82, v82 quad_perm:[1,0,3,2] row_mask:0xf bank_mask:0xf
    v_add_f32_dpp v83, v83, v83 quad_perm:[1,0,3,2] row_mask:0xf bank_mask:0xf
    v_cvt_pk_bf16_f32 v52, v76, v77
    v_cvt_pk_bf16_f32 v53, v78, v79
    v_cvt_pk_bf16_f32 v54, v80, v81
    v_cvt_pk_bf16_f32 v55, v82, v83
    ds_write2_b32 v10, v52, v53 offset0:0 offset1:8
    ds_write2_b32 v10, v54, v55 offset0:4 offset1:12
    s_waitcnt lgkmcnt(0)
    s_barrier
    ds_read_b128 v[84:87], v24
    ds_read_b128 v[88:91], v25
    ds_read_b128 v[92:95], v26
    ds_read_b128 v[96:99], v27
    s_lshr_b32 s7, s2, 5
    s_cmp_lg_u32 s7, 1
    s_cbranch_scc1 L_w_nohf
    s_cmp_lg_u32 s3, 3
    s_cbranch_scc1 L_w_nohf
    s_mov_b32 exec_hi, 0
    buffer_store_dword v125, v124, s[36:39], s5 offen sc1
    s_mov_b64 exec, -1
L_w_nohf:
    s_waitcnt lgkmcnt(3)
    v_smfmac_f32_16x16x64_bf16 v[192:195], v[84:87], a[0:7], v6
    v_smfmac_f32_16x16x64_bf16 v[196:199], v[84:87], a[16:23], v6
    v_smfmac_f32_16x16x64_bf16 v[200:203], v[84:87], a[32:39], v6
    v_smfmac_f32_16x16x64_bf16 v[204:207], v[84:87], a[48:55], v6
    s_waitcnt lgkmcnt(2)
    v_smfmac_f32_16x16x64_bf16 v[192:195], v[88:91], a[64:71], v6
    v_smfmac_f32_16x16x64_bf16 v[196:199], v[88:91], a[80:87], v6
    v_smfmac_f32_16x16x64_bf16 v[200:203], v[88:91], a[96:103], v6
    v_smfmac_f32_16x16x64_bf16 v[204:207], v[88:91], a[112:119], v6
    s_waitcnt lgkmcnt(1)
    v_smfmac_f32_16x16x64_bf16 v[192:195], v[92:95], a[8:15], v6
    v_smfmac_f32_16x16x64_bf16 v[196:199], v[92:95], a[24:31], v6
    v_smfmac_f32_16x16x64_bf16 v[200:203], v[92:95], a[40:47], v6
    v_smfmac_f32_16x16x64_bf16 v[204:207], v[92:95], a[56:63], v6
    s_waitcnt lgkmcnt(0)
    v_smfmac_f32_16x16x64_bf16 v[192:195], v[96:99], a[72:79], v6
    v_smfmac_f32_16x16x64_bf16 v[196:199], v[96:99], a[88:95], v6
    v_smfmac_f32_16x16x64_bf16 v[200:203], v[96:99], a[104:111], v6
    v_smfmac_f32_16x16x64_bf16 v[204:207], v[96:99], a[120:127], v6
    s_nop 4
    v_add_f32 v52, v192, v193
    v_add_f32 v53, v196, v197
    v_add_f32 v54, v200, v201
    v_add_f32 v55, v204, v205
    v_and_or_b32 v52, v52, v102, s17
    v_and_or_b32 v53, v53, v102, s17
    v_and_or_b32 v54, v54, v102, s17
    v_and_or_b32 v55, v55, v102, s17
    buffer_store_dwordx4 v[52:55], v100, s[36:39], s52 offen sc1
    s_cmp_lg_u32 s3, 0
    s_cbranch_scc1 L_w_end
    s_add_u32 s52, s32, 0
    s_add_u32 s56, s32, 524288
    s_add_u32 s53, s32, 4096
    s_add_u32 s57, s32, 528384
    s_add_u32 s54, s32, 8192
    s_add_u32 s58, s32, 532480
    s_add_u32 s55, s32, 12288
    s_add_u32 s59, s32, 536576
    s_mov_b32 s68, 0x00030003
    s_mov_b32 s69, 0x00030003
    s_add_u32 s34, s6, 1310720
    buffer_load_dword v31, v103, s[36:39], s34 offen sc1
    s_waitcnt vmcnt(0)
    s_mov_b32 s67, 0
L_w_hf:
    v_cmp_ne_u32 vcc, s16, v31
    s_nop 0
    s_cbranch_vccz L_w_hf_ok
    s_add_u32 s67, s67, 1
    s_cmp_ge_u32 s67, 150000
    s_cbranch_scc1 L_w_hf_ok
    buffer_load_dword v31, v103, s[36:39], s34 offen sc1
    s_waitcnt vmcnt(0)
    s_branch L_w_hf
L_w_hf_ok:
    s_mov_b32 s67, 0
L_f_a:
    buffer_load_dwordx4 v[160:163], v13, s[36:39], s56 offen sc1
    buffer_load_dwordx4 v[164:167], v13, s[36:39], s57 offen sc1
    buffer_load_dwordx4 v[168:171], v13, s[36:39], s58 offen sc1
    buffer_load_dwordx4 v[172:175], v12, s[36:39], s59 offen sc1
    buffer_load_dwordx4 v[128:131], v13, s[36:39], s52 offen sc1
    buffer_load_dwordx4 v[132:135], v13, s[36:39], s53 offen sc1
    buffer_load_dwordx4 v[136:139], v13, s[36:39], s54 offen sc1
    buffer_load_dwordx4 v[140:143], v13, s[36:39], s55 offen sc1
    s_add_u32 s67, s67, 1
    s_waitcnt vmcnt(7)
    v_xor_b32 v160, s17, v160
    v_xor_b32 v161, s17, v161
    v_xor_b32 v162, s17, v162
    v_xor_b32 v163, s17, v163
    v_or3_b32 v21, v160, v161, v162
    v_or_b32 v21, v21, v163
    s_waitcnt vmcnt(6)
    v_xor_b32 v164, s17, v164
    v_xor_b32 v165, s17, v165
    v_xor_b32 v166, s17, v166
    v_xor_b32 v167, s17, v167
    v_or3_b32 v21, v21, v164, v165
    v_or3_b32 v21, v21, v166, v167
    v_pk_add_f32 v[40:41], v[160:161], v[164:165]
    v_pk_add_f32 v[42:43], v[162:163], v[166:167]
    s_waitcnt vmcnt(5)
    v_xor_b32 v168, s17, v168
    v_xor_b32 v169, s17, v169
    v_xor_b32 v170, s17, v170
    v_xor_b32 v171, s17, v171
    v_or3_b32 v21, v21, v168, v169
    v_or3_b32 v21, v21, v170, v171
    v_pk_add_f32 v[40:41], v[40:41], v[168:169]
    v_pk_add_f32 v[42:43], v[42:43], v[170:171]
    s_waitcnt vmcnt(4)
    s_mov_b32 exec_hi, 0
    v_xor_b32 v172, s17, v172
    v_xor_b32 v173, s17, v173
    v_xor_b32 v174, s17, v174
    v_xor_b32 v175, s17, v175
    v_or3_b32 v21, v21, v172, v173
    v_or3_b32 v21, v21, v174, v175
    s_mov_b32 exec_hi, -1
    v_pk_add_f32 v[40:41], v[40:41], v[172:173]
    v_pk_add_f32 v[42:43], v[42:43], v[174:175]
    s_nop 0
    v_add_f32_dpp v40, v40, v40 row_ror:2 row_mask:0xf bank_mask:0xf
    v_add_f32_dpp v41, v41, v41 row_ror:2 row_mask:0xf bank_mask:0xf
    v_add_f32_dpp v42, v42, v42 row_ror:2 row_mask:0xf bank_mask:0xf
    v_add_f32_dpp v43, v43, v43 row_ror:2 row_mask:0xf bank_mask:0xf
    v_add_f32_dpp v40, v40, v40 row_ror:4 row_mask:0xf bank_mask:0xf
    v_add_f32_dpp v41, v41, v41 row_ror:4 row_mask:0xf bank_mask:0xf
    v_add_f32_dpp v42, v42, v42 row_ror:4 row_mask:0xf bank_mask:0xf
    v_add_f32_dpp v43, v43, v43 row_ror:4 row_mask:0xf bank_mask:0xf
    v_add_f32_dpp v40, v40, v40 row_ror:8 row_mask:0xf bank_mask:0xf
    v_add_f32_dpp v41, v41, v41 row_ror:8 row_mask:0xf bank_mask:0xf
    v_add_f32_dpp v42, v42, v42 row_ror:8 row_mask:0xf bank_mask:0xf
    v_add_f32_dpp v43, v43, v43 row_ror:8 row_mask:0xf bank_mask:0xf
    v_permlane16_swap_b32 v40, v41
    s_nop 0
    v_permlane16_swap_b32 v42, v43
    v_add_f32 v40, v40, v41
    v_add_f32 v42, v42, v43
    s_nop 1
    v_permlane32_swap_b32 v40, v42
    v_add_f32 v40, v40, v42
    v_cvt_pk_bf16_f32 v40, v40, v40
    v_and_b32 v40, 0xffff0000, v40
    v_mul_f32 v22, v30, v40
    v_cvt_pk_bf16_f32 v22, v22, v22
    v_and_b32 v22, 0xffff0000, v22
    v_and_b32 v21, 0xff, v21
    v_cmp_ne_u32 s[10:11], 0, v21
L_f_a2:
    s_waitcnt vmcnt(3)
    v_xor_b32 v128, s17, v128
    v_xor_b32 v129, s17, v129
    v_xor_b32 v130, s17, v130
    v_xor_b32 v131, s17, v131
    v_or3_b32 v21, v128, v129, v130
    v_or_b32 v21, v21, v131
    s_waitcnt vmcnt(2)
    v_xor_b32 v132, s17, v132
    v_xor_b32 v133, s17, v133
    v_xor_b32 v134, s17, v134
    v_xor_b32 v135, s17, v135
    v_or3_b32 v21, v21, v132, v133
    v_or3_b32 v21, v21, v134, v135
    v_pk_add_f32 v[44:45], v[128:129], v[132:133]
    v_pk_add_f32 v[46:47], v[130:131], v[134:135]
    s_waitcnt vmcnt(1)
    v_xor_b32 v136, s17, v136
    v_xor_b32 v137, s17, v137
    v_xor_b32 v138, s17, v138
    v_xor_b32 v139, s17, v139
    v_or3_b32 v21, v21, v136, v137
    v_or3_b32 v21, v21, v138, v139
    v_pk_add_f32 v[44:45], v[44:45], v[136:137]
    v_pk_add_f32 v[46:47], v[46:47], v[138:139]
    s_waitcnt vmcnt(0)
    v_xor_b32 v140, s17, v140
    v_xor_b32 v141, s17, v141
    v_xor_b32 v142, s17, v142
    v_xor_b32 v143, s17, v143
    v_or3_b32 v21, v21, v140, v141
    v_or3_b32 v21, v21, v142, v143
    v_pk_add_f32 v[44:45], v[44:45], v[140:141]
    v_pk_add_f32 v[46:47], v[46:47], v[142:143]
    v_and_b32 v21, 0xff, v21
    v_cmp_ne_u32 vcc, 0, v21
    s_nop 0
    s_or_b64 s[8:9], vcc, s[10:11]
    s_cbranch_scc0 L_f_a_ok
    s_cmp_ge_u32 s67, 150000
    s_cbranch_scc1 L_f_a_ok
    s_cmp_lg_u64 s[10:11], 0
    s_cbranch_scc1 L_f_a
    s_add_u32 s67, s67, 1
    buffer_load_dwordx4 v[128:131], v13, s[36:39], s52 offen sc1
    buffer_load_dwordx4 v[132:135], v13, s[36:39], s53 offen sc1
    buffer_load_dwordx4 v[136:139], v13, s[36:39], s54 offen sc1
    buffer_load_dwordx4 v[140:143], v13, s[36:39], s55 offen sc1
    s_branch L_f_a2
L_f_a_ok:
    v_add_f32_dpp v44, v44, v44 row_ror:2 row_mask:0xf bank_mask:0xf
    v_add_f32_dpp v45, v45, v45 row_ror:2 row_mask:0xf bank_mask:0xf
    v_add_f32_dpp v46, v46, v46 row_ror:2 row_mask:0xf bank_mask:0xf
    v_add_f32_dpp v47, v47, v47 row_ror:2 row_mask:0xf bank_mask:0xf
    v_add_f32_dpp v44, v44, v44 row_ror:4 row_mask:0xf bank_mask:0xf
    v_add_f32_dpp v45, v45, v45 row_ror:4 row_mask:0xf bank_mask:0xf
    v_add_f32_dpp v46, v46, v46 row_ror:4 row_mask:0xf bank_mask:0xf
    v_add_f32_dpp v47, v47, v47 row_ror:4 row_mask:0xf bank_mask:0xf
    v_add_f32_dpp v44, v44, v44 row_ror:8 row_mask:0xf bank_mask:0xf
    v_add_f32_dpp v45, v45, v45 row_ror:8 row_mask:0xf bank_mask:0xf
    v_add_f32_dpp v46, v46, v46 row_ror:8 row_mask:0xf bank_mask:0xf
    v_add_f32_dpp v47, v47, v47 row_ror:8 row_mask:0xf bank_mask:0xf
    v_permlane16_swap_b32 v44, v45
    s_nop 0
    v_permlane16_swap_b32 v46, v47
    v_add_f32 v44, v44, v45
    v_add_f32 v46, v46, v47
    s_nop 1
    v_permlane32_swap_b32 v44, v46
    v_add_f32 v44, v44, v46
    v_cvt_pk_bf16_f32 v44, v44, v44
    v_and_b32 v44, 0xffff0000, v44
    v_mul_f32 v23, v29, v44
    v_cvt_pk_bf16_f32 v23, v23, v23
    v_and_b32 v23, 0xffff0000, v23
    v_add_f32 v23, v23, v22
    v_cvt_pk_bf16_f32 v23, v23, v23
    s_mov_b64 exec, s[68:69]
    buffer_store_short v23, v14, s[24:27], s35 offen
L_w_end:
    s_endpgm
L_exit:
    s_endpgm
.section .rodata,"a"
.p2align 6
.amdhsa_kernel gated_mix__compressed_kv_cla__dense_activation_silu__decode_kernel
  .amdhsa_next_free_vgpr 512
  .amdhsa_next_free_sgpr 102
  .amdhsa_accum_offset 256
  .amdhsa_group_segment_fixed_size 0
  .amdhsa_kernarg_size 104
  .amdhsa_user_sgpr_count 2
  .amdhsa_user_sgpr_kernarg_segment_ptr 1
  .amdhsa_system_sgpr_workgroup_id_x 1
.end_amdhsa_kernel
```
